```python
import torch

def _softmax(x, axis=-1):
    return torch.softmax(x, dim=axis)
def _gelu(x):
    return torch.nn.functional.gelu(x, approximate="tanh")
def _silu(x):
    return torch.nn.functional.silu(x)
def _sigmoid(x):
    return torch.sigmoid(x)
def _layernorm(x, axis=-1, eps=1e-5):
    m = x.mean(dim=axis, keepdim=True)
    v = x.var(dim=axis, keepdim=True, unbiased=False)
    return (x - m) / torch.sqrt(v + eps)
def _scatter_add(tgt, idx, src, axis=0):
    return tgt.clone().index_add_(axis, idx, src)
def _segment_sum(src, seg, n):
    out = torch.zeros((n,) + src.shape[1:], dtype=src.dtype)
    return out.index_add_(0, seg, src)
def _pad(x, pw):
    flat = tuple(v for pair in reversed(pw) for v in pair)
    return torch.nn.functional.pad(x, flat)

kernel_name = 'parallel_sum__softmax_full_mha__swiglu_ffn__prompt'

def setup_inputs():

    _w = (lambda a: (lambda t: t.to(torch.bfloat16) if t.is_floating_point() else t)(torch.as_tensor(a)))
    def _A_setup():
        B, S, D = 1, 2048, 512
        return {
            "x": _w((lambda *s: torch.randn(*s, dtype=torch.bfloat16) * 0.05)(B, S, D)),
            "wqkv": _w((lambda *s: torch.randn(*s, dtype=torch.bfloat16) * 0.2)(D, 3 * D)),
            "wo": _w((lambda *s: torch.randn(*s, dtype=torch.bfloat16) * 0.1)(D, D)),
        }
    _A_in = _A_setup()

    def _B_setup():
        B, S, D, F = 1, 2048, 512, 1792
        return {
            "x": _w((lambda *s: torch.randn(*s, dtype=torch.bfloat16) * 0.05)(B, S, D)),
            "w_gate": _w((lambda *s: torch.randn(*s, dtype=torch.bfloat16) * 0.1)(D, F)),
            "w_up": _w((lambda *s: torch.randn(*s, dtype=torch.bfloat16) * 0.1)(D, F)),
            "w_down": _w((lambda *s: torch.randn(*s, dtype=torch.bfloat16) * 0.1)(F, D)),
        }
    _B_in = _B_setup()

    return {
        "A_x": _A_in["x"],
        "A_wqkv": _A_in["wqkv"],
        "A_wo": _A_in["wo"],
        "B_x": _B_in["x"],
        "B_w_gate": _B_in["w_gate"],
        "B_w_up": _B_in["w_up"],
        "B_w_down": _B_in["w_down"],
    }

def reference(A_x, A_wqkv, A_wo, B_x, B_w_gate, B_w_up, B_w_down):
    def _A_ref(x, wqkv, wo):
        B, S, D = x.shape
        H = 32; Dh = D // H
        qkv = (lambda x, *d: x.permute(*d))((x @ wqkv).reshape(B, S, 3, H, Dh), 2, 0, 3, 1, 4)
        q, k, v = qkv[0], qkv[1], qkv[2]
        scale = Dh ** -0.5
        scores = torch.einsum("bhqd,bhkd->bhqk", q, k) * scale
        p = _softmax(scores, axis=-1)
        o = torch.einsum("bhqk,bhkd->bhqd", p, v)
        return (lambda x, *d: x.permute(*d))(o, 0, 2, 1, 3).reshape(B, S, D) @ wo

    def _B_ref(x, w_gate, w_up, w_down):
        g = _silu(x @ w_gate)
        u = x @ w_up
        return (g * u) @ w_down

    x = A_x
    xn = _layernorm(x, axis=-1)
    return x + _A_ref(xn, A_wqkv, A_wo) + _B_ref(xn, B_w_gate, B_w_up, B_w_down)
```

```asm
; @launch grid=(256,1,1) block=(512,1,1) lds=163840
.amdgcn_target "amdgcn-amd-amdhsa--gfx950"
.text
.globl parallel_sum__softmax_full_mha__swiglu_ffn__prompt_kernel
.p2align 8
.type parallel_sum__softmax_full_mha__swiglu_ffn__prompt_kernel,@function
parallel_sum__softmax_full_mha__swiglu_ffn__prompt_kernel:
    s_cmp_ge_u32 s2, 256
    s_cbranch_scc1 L_end
    s_load_dwordx4 s[4:7], s[0:1], 0
    s_load_dwordx4 s[12:15], s[0:1], 32
    s_load_dwordx4 s[16:19], s[0:1], 64
    s_load_dwordx2 s[8:9], s[0:1], 16
    s_load_dwordx2 s[10:11], s[0:1], 48
    s_load_dwordx2 s[98:99], s[0:1], 56
    s_getpc_b64 s[32:33]
L_pc:
    s_mov_b32 s34, L_code_end-L_pc
    s_mov_b32 s35, 0x00020000
    v_lshlrev_b32 v5, 7, v0
    buffer_load_dword v9, v5, s[32:35], 0 offen
    s_mov_b64 s[100:101], s[32:33]
    v_lshrrev_b32 v5, 6, v0
    v_and_b32 v1, 63, v0
    v_lshlrev_b32 v4, 4, v1
    v_readfirstlane_b32 s3, v5
    s_and_b32 s37, s2, 1
    s_lshl_b32 s37, s37, 2
    s_bfe_u32 s47, s2, 0x20003
    s_add_u32 s37, s37, s47
    s_and_b32 s47, s2, 6
    s_mul_i32 s38, s47, 3
    s_add_u32 s47, s47, 18
    s_cmp_lt_u32 s2, 192
    s_cselect_b32 s38, s38, s47
    s_lshr_b32 s47, s2, 5
    s_add_u32 s38, s38, s47
    s_and_b32 s36, s3, 3
    v_lshrrev_b32 v5, 2, v1
    v_and_b32 v6, 3, v1
    v_mov_b32 v2, 0
    v_mov_b32 v8, 1
    s_mov_b32 s63, 200000
    s_mov_b32 s22, 2097152
    s_mov_b32 s23, 0x00020000
    s_cmp_ge_u32 s3, 4
    s_cbranch_scc1 L_help
    s_lshl_b32 s44, s37, 5
    s_add_u32 s44, s44, s38
    s_lshl_b32 s44, s44, 2
    s_add_u32 s44, s44, s36
    s_lshl_b32 s41, s44, 11
    v_lshrrev_b32 v7, 5, v1
    v_lshl_add_u32 v61, v7, 9, v4
    s_memrealtime s[96:97]
    s_mov_b32 s58, 256
    s_mov_b32 s59, 0x00020000
    s_or_b32 s47, s2, s3
    s_waitcnt lgkmcnt(0)
    s_mov_b64 s[20:21], s[4:5]
    s_mov_b64 s[56:57], s[16:17]
    s_cbranch_scc1 L_notag
    s_or_b32 s47, s96, 1
    v_mov_b32 v62, s47
    v_mov_b32 v63, 0
    s_mov_b64 exec, 1
    buffer_atomic_cmpswap v[62:63], v2, s[56:59], 0 offen sc1
    s_mov_b64 exec, -1
L_notag:
    buffer_load_dwordx4 v[48:51], v61, s[20:23], s41 offen
    buffer_load_dwordx4 v[52:55], v61, s[20:23], s41 offen offset:512
    s_branch L_mfma
L_help:
    v_lshrrev_b32 v131, 5, v1
    v_xor_b32 v131, v131, v6
    s_lshl_b32 s42, s38, 7
    s_mov_b32 s40, 3584
    s_mov_b32 s62, 64
    s_cmp_lt_u32 s38, 24
    s_cbranch_scc1 L_ta
    s_sub_u32 s47, s42, 1024
    s_lshr_b32 s42, s42, 1
    s_add_u32 s42, s42, 1536
    s_bitcmp1_b32 s36, 0
    s_cselect_b32 s42, s42, s47
    s_cselect_b32 s40, s40, 3072
    s_cselect_b32 s62, 0, 64
L_ta:
    s_lshl_b32 s26, s40, 9
    s_lshl_b32 s43, s40, 6
    s_mov_b32 s34, s26
    s_mov_b32 s27, 0x00020000
    s_lshr_b32 s47, s36, 1
    s_mul_i32 s48, s47, s40
    s_lshl_b32 s48, s48, 5
    s_add_u32 s42, s42, s48
    v_mul_u32_u24 v132, s40, v5
    v_lshl_add_u32 v132, v131, 4, v132
    s_lshl_b32 s48, s40, 4
    s_sub_u32 s48, s48, 1024
    v_add_u32 v133, s48, v132
    s_and_b32 s50, s36, 1
    s_lshl_b32 s50, s50, 1
    s_add_u32 s50, s50, s47
    s_lshl_b32 s50, s50, 11
    s_add_u32 s50, s50, 36864
    s_mul_i32 s51, s36, 49152
    s_lshl_b32 s47, s38, 5
    s_add_u32 s51, s51, s47
    v_mul_u32_u24 v134, 3072, v5
    v_lshl_add_u32 v134, v131, 4, v134
    v_lshrrev_b32 v7, 1, v6
    v_mul_u32_u24 v7, 992, v7
    v_add_u32 v134, v7, v134
    s_lshl_b32 s60, s36, 10
    s_add_u32 s60, s60, 32768
    s_mov_b32 s54, 1572864
    s_mov_b32 s55, 0x00020000
    s_mov_b32 s44, 0
    v_lshrrev_b32 v7, 4, v1
    v_and_b32 v128, 7, v1
    v_xor_b32 v7, v7, v128
    v_lshlrev_b32 v7, 4, v7
    v_lshrrev_b32 v128, 3, v1
    v_lshl_add_u32 v128, v128, 10, v7
    v_xor_b32 v129, 64, v128
    v_add_u32 v129, 7168, v129
    v_add_u32 v130, 14336, v128
    v_add_u32 v131, 14336, v129
    s_lshl_b32 s41, s37, 2
    s_add_u32 s41, s41, s36
    s_lshl_b32 s41, s41, 16
    s_lshl_b32 s49, s36, 13
    s_mov_b32 s39, 128
    s_mov_b32 s40, 196608
    s_cmp_lt_u32 s37, 4
    s_cbranch_scc1 L_fwd
    s_add_u32 s41, s41, 896
    s_mul_i32 s47, s43, 7
    s_add_u32 s42, s42, s47
    s_add_u32 s51, s51, 1376256
    s_mov_b32 s39, -128
    s_mov_b32 s40, -196608
    s_sub_u32 s43, 0, s43
L_fwd:
    s_waitcnt lgkmcnt(0)
    s_mov_b64 s[20:21], s[4:5]
    s_mov_b64 s[52:53], s[6:7]
    s_cmp_lt_u32 s38, 24
    s_cselect_b64 s[24:25], s[14:15], s[12:13]
    s_cselect_b64 s[32:33], s[12:13], s[6:7]
    s_bitcmp1_b32 s36, 0
    s_cselect_b64 s[24:25], s[24:25], s[32:33]
    s_cselect_b64 s[32:33], s[14:15], s[32:33]
    s_add_u32 s47, s44, s50
    s_add_u32 s48, s47, 8192
    s_add_u32 s97, s42, s62
    s_mov_b32 m0, s47
    s_nop 0
    buffer_load_dwordx4 v132, s[24:27], s42 offen offset:0 lds
    s_mov_b32 m0, s48
    s_nop 0
    buffer_load_dwordx4 v132, s[32:35], s97 offen offset:0 lds
    s_mov_b32 m0, s47
    s_nop 0
    buffer_load_dwordx4 v133, s[24:27], s42 offen offset:1024 lds
    s_mov_b32 m0, s48
    s_nop 0
    buffer_load_dwordx4 v133, s[32:35], s97 offen offset:1024 lds
    s_add_u32 m0, s44, s60
    s_add_u32 s42, s42, s43
    buffer_load_dwordx4 v134, s[52:55], s51 offen lds
    s_add_u32 s51, s51, s40
    s_add_u32 s47, s44, s49
    s_mov_b32 m0, s47
    s_add_u32 s96, s41, 32768
    buffer_load_dwordx4 v128, s[20:23], s41 offen offset:0 lds
    buffer_load_dwordx4 v129, s[20:23], s41 offen offset:1024 lds
    buffer_load_dwordx4 v130, s[20:23], s41 offen offset:2048 lds
    buffer_load_dwordx4 v131, s[20:23], s41 offen offset:3072 lds
    s_mov_b32 s28, s18
    s_mov_b32 s29, s19
    s_mov_b32 s30, 33554432
    s_mov_b32 s31, 0x00020000
    s_mov_b32 s56, s16
    s_mov_b32 s57, s17
    s_mov_b32 s58, 256
    s_mov_b32 s59, 0x00020000
    v_lshlrev_b32 v24, 3, v1
    v_lshlrev_b32 v22, 10, v5
    v_lshl_add_u32 v22, v6, 4, v22
    s_add_u32 m0, s47, 4096
    s_add_u32 s41, s41, s39
    buffer_load_dwordx4 v128, s[20:23], s96 offen offset:0 lds
    s_lshl_b32 s0, s36, 10
    s_add_u32 s0, s0, 111616
    v_add_u32 v25, s0, v4
    s_lshl_b32 s0, s36, 8
    s_add_u32 s0, s0, 115712
    v_lshl_add_u32 v26, v1, 2, s0
    v_lshrrev_b32 v7, 5, v1
    v_bfe_u32 v5, v1, 4, 1
    v_and_b32 v27, 12, v1
    v_lshrrev_b32 v135, 4, v1
    v_lshlrev_b32 v135, 9, v135
    buffer_load_dwordx4 v129, s[20:23], s96 offen offset:1024 lds
    v_lshl_add_u32 v135, v27, 4, v135
    v_and_b32 v28, 1, v1
    v_lshl_add_u32 v135, v28, 3, v135
    v_and_b32 v28, 2, v1
    v_lshl_add_u32 v135, v28, 4, v135
    v_lshl_add_u32 v135, v5, 4, v135
    s_and_b32 s1, s36, 1
    s_lshl_b32 s1, s1, 4
    v_xor_b32 v135, s1, v135
    s_and_b32 s0, s37, 3
    s_cmp_eq_u32 s0, 3
    s_cselect_b32 s0, 0, s0
    buffer_load_dwordx4 v130, s[20:23], s96 offen offset:2048 lds
    s_mul_i32 s0, s0, 53248
    s_add_u32 s0, s0, 32768
    s_lshr_b32 s1, s36, 1
    s_lshl_b32 s1, s1, 12
    s_add_u32 s0, s0, s1
    v_add_u32 v135, s0, v135
    v_and_b32 v28, 31, v1
    v_mul_u32_u24 v136, 1280, v7
    v_lshl_add_u32 v136, v28, 3, v136
    v_lshlrev_b32 v28, 5, v28
    v_lshl_add_u32 v28, v7, 2, v28
    buffer_load_dwordx4 v131, s[20:23], s96 offen offset:3072 lds
    s_lshl_b32 s0, s36, 3
    s_add_u32 s0, s0, 106496
    v_add_u32 v28, s0, v28
    v_lshlrev_b32 v20, 8, v7
    v_lshl_add_u32 v20, v27, 4, v20
    v_lshl_add_u32 v20, v5, 5, v20
    v_lshl_add_u32 v20, v6, 3, v20
    s_mul_i32 s0, s36, 3072
    s_add_u32 s0, s0, 147456
    v_add_u32 v20, s0, v20
    v_and_b32 v23, 15, v1
    s_add_u32 s44, s44, 53248
    s_cmp_eq_u32 s44, 159744
    s_cselect_b32 s44, 0, s44
    s_add_u32 s47, s44, s50
    s_add_u32 s48, s47, 8192
    s_add_u32 s97, s42, s62
    s_mov_b32 m0, s47
    s_nop 0
    buffer_load_dwordx4 v132, s[24:27], s42 offen offset:0 lds
    v_lshlrev_b32 v13, 10, v23
    v_lshl_add_u32 v13, v5, 5, v13
    v_lshl_add_u32 v13, v7, 4, v13
    v_lshlrev_b32 v23, 4, v23
    v_lshl_add_u32 v23, v5, 9, v23
    v_lshl_add_u32 v23, v7, 10, v23
    v_mov_b32 v40, 0x3f803f80
    v_mov_b32 v32, 0
    v_mov_b32 v36, -1
    v_mov_b32 v41, 0x3f803f80
    v_mov_b32 v33, 0
    s_mov_b32 m0, s48
    s_nop 0
    buffer_load_dwordx4 v132, s[32:35], s97 offen offset:0 lds
    v_mov_b32 v37, -1
    v_mov_b32 v42, 0x3f803f80
    v_mov_b32 v34, 0
    v_mov_b32 v38, -1
    v_mov_b32 v43, 0x3f803f80
    v_mov_b32 v35, 0
    v_mov_b32 v39, -1
    v_lshrrev_b32 v21, 1, v1
    v_lshlrev_b32 v21, 11, v21
    v_and_b32 v5, 1, v1
    v_lshl_add_u32 v21, v5, 8, v21
    s_mov_b32 m0, s47
    s_nop 0
    buffer_load_dwordx4 v133, s[24:27], s42 offen offset:1024 lds
    v_add_u32 v21, 131072, v21
    v_mfma_f32_32x32x16_bf16 v[80:95], v[32:35], v[32:35], 0
    v_mfma_f32_32x32x16_bf16 v[96:111], v[32:35], v[32:35], 0
    v_mfma_f32_32x32x16_bf16 v[112:127], v[32:35], v[32:35], 0
    v_add_u32 v14, s37, v1
    v_and_b32 v14, 7, v14
    v_lshlrev_b32 v14, 8, v14
    s_lshr_b32 s0, s38, 2
    s_add_u32 s0, s0, 24
    s_lshl_b32 s0, s0, 11
    s_add_u32 s0, s0, 16
    s_mov_b32 m0, s48
    s_nop 0
    buffer_load_dwordx4 v133, s[32:35], s97 offen offset:1024 lds
    s_lshl_b32 s1, s38, 11
    v_mov_b32 v5, s1
    s_mov_b64 exec, 0xff
    v_mov_b32 v5, s0
    s_mov_b64 exec, -1
    v_add_u32 v14, v5, v14
    s_lshl_b32 s0, s36, 11
    v_add_u32 v10, s0, v4
    v_mov_b32 v18, 159744
    v_lshlrev_b32 v15, 11, v1
    v_lshlrev_b32 v17, 7, v1
    s_lshl_b32 s0, s36, 13
    v_add_u32 v19, s0, v4
    s_add_u32 m0, s44, s60
    s_add_u32 s42, s42, s43
    buffer_load_dwordx4 v134, s[52:55], s51 offen lds
    v_xor_b32 v11, 0x4000, v19
    v_xor_b32 v12, 0xa000, v19
    s_lshl_b32 s61, s37, 2
    s_add_u32 s61, s61, s36
    s_lshl_b32 s61, s61, 9
    s_add_u32 s61, s61, 23068672
    s_and_b32 s45, s37, 3
    s_sub_u32 s45, 5, s45
    s_add_u32 s51, s51, s40
    s_waitcnt vmcnt(5)
    s_barrier
    ds_read_b32 v3, v18 offset:32
    s_mov_b32 s46, 5
L_hloopx:
    s_add_u32 s47, s44, s49
    s_mov_b32 m0, s47
    s_add_u32 s96, s41, 32768
    buffer_load_dwordx4 v128, s[20:23], s41 offen offset:0 lds
    buffer_load_dwordx4 v129, s[20:23], s41 offen offset:1024 lds
    buffer_load_dwordx4 v130, s[20:23], s41 offen offset:2048 lds
    buffer_load_dwordx4 v131, s[20:23], s41 offen offset:3072 lds
    s_add_u32 m0, s47, 4096
    s_add_u32 s41, s41, s39
    buffer_load_dwordx4 v128, s[20:23], s96 offen offset:0 lds
    buffer_load_dwordx4 v129, s[20:23], s96 offen offset:1024 lds
    buffer_load_dwordx4 v130, s[20:23], s96 offen offset:2048 lds
    buffer_load_dwordx4 v131, s[20:23], s96 offen offset:3072 lds
    s_add_u32 s44, s44, 53248
    s_cmp_eq_u32 s44, 159744
    s_cselect_b32 s44, 0, s44
L_hloop:
    s_add_u32 s47, s44, s50
    s_add_u32 s48, s47, 8192
    s_add_u32 s97, s42, s62
    s_mov_b32 m0, s47
    s_nop 0
    buffer_load_dwordx4 v132, s[24:27], s42 offen offset:0 lds
    s_mov_b32 m0, s48
    s_nop 0
    buffer_load_dwordx4 v132, s[32:35], s97 offen offset:0 lds
    s_mov_b32 m0, s47
    s_nop 0
    buffer_load_dwordx4 v133, s[24:27], s42 offen offset:1024 lds
    s_mov_b32 m0, s48
    s_nop 0
    buffer_load_dwordx4 v133, s[32:35], s97 offen offset:1024 lds
    s_add_u32 m0, s44, s60
    s_add_u32 s42, s42, s43
    buffer_load_dwordx4 v134, s[52:55], s51 offen lds
    s_add_u32 s51, s51, s40
    s_cmp_gt_i32 s46, 2
    s_cbranch_scc1 L_hskew
    s_add_u32 s47, s44, s49
    s_mov_b32 m0, s47
    s_add_u32 s96, s41, 32768
    buffer_load_dwordx4 v128, s[20:23], s41 offen offset:0 lds
    buffer_load_dwordx4 v129, s[20:23], s41 offen offset:1024 lds
    buffer_load_dwordx4 v130, s[20:23], s41 offen offset:2048 lds
    buffer_load_dwordx4 v131, s[20:23], s41 offen offset:3072 lds
    s_add_u32 m0, s47, 4096
    s_add_u32 s41, s41, s39
    buffer_load_dwordx4 v128, s[20:23], s96 offen offset:0 lds
    buffer_load_dwordx4 v129, s[20:23], s96 offen offset:1024 lds
    buffer_load_dwordx4 v130, s[20:23], s96 offen offset:2048 lds
    buffer_load_dwordx4 v131, s[20:23], s96 offen offset:3072 lds
    s_add_u32 s44, s44, 53248
    s_cmp_eq_u32 s44, 159744
    s_cselect_b32 s44, 0, s44
    s_cmp_eq_u32 s46, s45
    s_cbranch_scc1 L_hcs
    s_waitcnt vmcnt(13)
L_hbar:
    s_barrier
    s_sub_u32 s46, s46, 1
    s_cbranch_scc0 L_hloop
L_h6:
    s_mul_i32 s41, s38, 10240
    s_mul_i32 s47, s36, 2560
    s_add_u32 s41, s41, s47
    s_add_u32 s41, s41, 23199744
    s_mov_b32 s7, 0x00020000
L_st:
    buffer_load_dwordx2 v[182:183], v24, s[28:31], s61 offen sc1
    buffer_load_dwordx2 v[188:189], v136, s[28:31], s41 offen offset:0 sc1
    buffer_load_dwordx2 v[190:191], v136, s[28:31], s41 offen offset:256 sc1
    buffer_load_dwordx2 v[192:193], v136, s[28:31], s41 offen offset:512 sc1
    buffer_load_dwordx2 v[194:195], v136, s[28:31], s41 offen offset:768 sc1
    buffer_load_dwordx2 v[196:197], v136, s[28:31], s41 offen offset:1024 sc1
    s_sub_u32 s63, s63, 1
    s_cbranch_scc1 L_end
    s_waitcnt vmcnt(0)
    v_xor_b32 v180, v3, v183
    v_xor_b32 v189, v3, v189
    v_xor_b32 v191, v3, v191
    v_xor_b32 v193, v3, v193
    v_xor_b32 v195, v3, v195
    v_xor_b32 v197, v3, v197
    v_or3_b32 v180, v180, v189, v191
    v_or3_b32 v180, v180, v193, v195
    v_or_b32 v180, v180, v197
    v_cmp_ne_u32 vcc, 0, v180
    s_nop 0
    s_cmp_eq_u64 vcc, 0
    s_cbranch_scc0 L_st
    ds_write_b32 v28, v188 offset:0
    ds_write_b32 v28, v190 offset:1024
    ds_write_b32 v28, v192 offset:2048
    ds_write_b32 v28, v194 offset:3072
    ds_write_b32 v28, v196 offset:4096
    v_and_b32 v183, 0xffff0000, v182
    v_and_b32 v182, 0xffff, v182
    v_rcp_f32 v183, v183
    v_lshl_or_b32 v184, v182, 16, v182
    v_lshl_or_b32 v185, v182, 16, v182
    v_lshl_or_b32 v186, v182, 16, v182
    v_lshl_or_b32 v187, v182, 16, v182
    ds_write_b32 v26, v183
    ds_write_b128 v25, v[184:187]
    s_mov_b64 s[4:5], s[100:101]
    s_mov_b32 s6, L_code_end-L_pc
    s_lshl_b32 s47, s36, 13
    s_add_u32 s47, s47, L_att-L_pc
    buffer_load_dword v9, v17, s[4:7], s47 offen
    s_branch L_h_done
L_hskew:
    s_cmp_eq_u32 s46, s45
    s_cbranch_scc1 L_hcs
    s_waitcnt vmcnt(5)
L_hbar2:
    s_barrier
    s_sub_u32 s46, s46, 1
    s_branch L_hloopx
L_hcs:
    ds_read_b64_tr_b16 v[156:157], v135 offset:0
    ds_read_b64_tr_b16 v[158:159], v135 offset:256
    ds_read_b64_tr_b16 v[160:161], v135 offset:2048
    ds_read_b64_tr_b16 v[162:163], v135 offset:2304
    ds_read_b64_tr_b16 v[164:165], v135 offset:8192
    ds_read_b64_tr_b16 v[166:167], v135 offset:8448
    ds_read_b64_tr_b16 v[168:169], v135 offset:10240
    ds_read_b64_tr_b16 v[170:171], v135 offset:10496
    ds_read_b64_tr_b16 v[172:173], v135 offset:16384
    ds_read_b64_tr_b16 v[174:175], v135 offset:16640
    ds_read_b64_tr_b16 v[176:177], v135 offset:18432
    ds_read_b64_tr_b16 v[178:179], v135 offset:18688
    s_lshl_b32 s47, s38, 3
    s_add_u32 s47, s47, s37
    s_mul_i32 s47, s47, 1280
    s_lshl_b32 s48, s36, 7
    s_add_u32 s47, s47, s48
    s_add_u32 s47, s47, 23199744
    s_waitcnt lgkmcnt(0)
    v_mfma_f32_16x16x32_bf16 v[144:147], v[40:43], v[156:159], 0
    v_mfma_f32_16x16x32_bf16 v[144:147], v[40:43], v[160:163], v[144:147]
    v_mfma_f32_16x16x32_bf16 v[148:151], v[40:43], v[164:167], 0
    v_mfma_f32_16x16x32_bf16 v[148:151], v[40:43], v[168:171], v[148:151]
    v_mfma_f32_16x16x32_bf16 v[152:155], v[40:43], v[172:175], 0
    v_mfma_f32_16x16x32_bf16 v[152:155], v[40:43], v[176:179], v[152:155]
    s_nop 5
    v_cvt_pk_bf16_f32 v145, v144, v144
    v_cvt_pk_bf16_f32 v149, v148, v148
    v_cvt_pk_bf16_f32 v153, v152, v152
    v_lshlrev_b32 v145, 16, v145
    v_lshlrev_b32 v149, 16, v149
    v_lshlrev_b32 v153, 16, v153
    v_sub_f32 v144, v144, v145
    v_sub_f32 v148, v148, v149
    v_sub_f32 v152, v152, v153
    v_cvt_pk_bf16_f32 v144, v145, v144
    v_cvt_pk_bf16_f32 v148, v149, v148
    v_cvt_pk_bf16_f32 v152, v153, v152
    v_mov_b32 v145, v3
    v_mov_b32 v149, v3
    v_mov_b32 v153, v3
    s_mov_b64 exec, 0xffff
    buffer_store_dwordx2 v[144:145], v24, s[28:31], s47 offen offset:0 sc1
    buffer_store_dwordx2 v[148:149], v24, s[28:31], s47 offen offset:512 sc1
    s_cmp_ge_u32 s36, 2
    s_cbranch_scc1 L_hcs2
    buffer_store_dwordx2 v[152:153], v24, s[28:31], s47 offen offset:1024 sc1
L_hcs2:
    s_mov_b64 exec, -1
    s_waitcnt vmcnt(15)
    s_cmp_le_i32 s46, 2
    s_cbranch_scc1 L_hbar
    s_waitcnt vmcnt(7)
    s_branch L_hbar2
L_mfma:
    s_mov_b32 s28, s18
    s_mov_b32 s29, s19
    s_mov_b32 s30, 33554432
    s_mov_b32 s31, 0x00020000
    s_lshl_b32 s49, s38, 3
    s_add_u32 s49, s49, s37
    s_lshl_b32 s49, s49, 6
    s_add_u32 s49, s49, s36
    s_lshl_b32 s49, s49, 2
    s_add_u32 s49, s49, 23592960
    v_mov_b32 v14, 159744
    v_mov_b64 v[16:17], 0
    v_mov_b64 v[18:19], 0
    ds_write_b128 v14, v[16:19]
    ds_write_b128 v14, v[16:19] offset:16
    v_mfma_f32_32x32x16_bf16 v[96:111], v[16:19], v[16:19], 0
    v_mfma_f32_32x32x16_bf16 v[112:127], v[16:19], v[16:19], 0
    v_mfma_f32_32x32x16_bf16 v[128:143], v[16:19], v[16:19], 0
    v_mfma_f32_32x32x16_bf16 v[144:159], v[16:19], v[16:19], 0
    v_mfma_f32_32x32x16_bf16 v[160:175], v[16:19], v[16:19], 0
    v_mfma_f32_32x32x16_bf16 v[176:191], v[16:19], v[16:19], 0
    v_mfma_f32_32x32x16_bf16 v[192:207], v[16:19], v[16:19], 0
    v_mfma_f32_32x32x16_bf16 v[208:223], v[16:19], v[16:19], 0
    v_mfma_f32_32x32x16_bf16 v[224:239], v[16:19], v[16:19], 0
    v_mfma_f32_32x32x16_bf16 v[240:255], v[16:19], v[16:19], 0
    v_and_b32 v10, 15, v1
    v_lshlrev_b32 v10, 7, v10
    v_bfe_u32 v11, v1, 1, 3
    v_lshrrev_b32 v12, 4, v1
    v_xor_b32 v11, v11, v12
    v_lshl_add_u32 v10, v11, 4, v10
    s_lshl_b32 s47, s36, 13
    v_add_u32 v10, s47, v10
    v_lshlrev_b32 v11, 9, v12
    v_and_b32 v5, 3, v5
    v_lshl_add_u32 v11, v5, 6, v11
    v_and_b32 v5, 1, v1
    v_lshl_add_u32 v11, v5, 3, v11
    v_and_b32 v5, 2, v1
    v_lshl_add_u32 v11, v5, 4, v11
    v_and_b32 v5, 16, v1
    v_add3_u32 v11, v5, v11, v2
    v_add_u32 v11, 32768, v11
    s_mov_b32 s45, 0
    v_add_u32 v12, s45, v10
    v_add_u32 v14, s45, v11
    v_xor_b32 v13, 64, v12
    v_xor_b32 v15, 16, v14
    v_mov_b32 v60, 0x3f803f80
    v_mov_b64 v[56:57], 0
    v_mov_b64 v[58:59], 0
    s_lshl_b32 s44, s44, 4
    s_add_u32 s44, s44, 23068672
    v_lshlrev_b32 v7, 3, v7
    s_waitcnt vmcnt(0)
    buffer_load_dword v3, v2, s[56:59], 0 offen sc1
    v_dot2c_f32_bf16 v56, v48, v60
    v_dot2c_f32_bf16 v57, v48, v48
    v_dot2c_f32_bf16 v58, v49, v60
    v_dot2c_f32_bf16 v59, v49, v49
    v_dot2c_f32_bf16 v56, v50, v60
    v_dot2c_f32_bf16 v57, v50, v50
    v_dot2c_f32_bf16 v58, v51, v60
    v_dot2c_f32_bf16 v59, v51, v51
    v_dot2c_f32_bf16 v56, v52, v60
    v_dot2c_f32_bf16 v57, v52, v52
    v_dot2c_f32_bf16 v58, v53, v60
    v_dot2c_f32_bf16 v59, v53, v53
    v_dot2c_f32_bf16 v56, v54, v60
    v_dot2c_f32_bf16 v57, v54, v54
    v_dot2c_f32_bf16 v58, v55, v60
    v_dot2c_f32_bf16 v59, v55, v55
    s_nop 2
    v_add_f32 v56, v56, v58
    v_add_f32 v57, v57, v59
    s_nop 0
    v_add_f32_dpp v56, v56, v56 quad_perm:[1,0,3,2] row_mask:0xf bank_mask:0xf
    v_add_f32_dpp v57, v57, v57 quad_perm:[1,0,3,2] row_mask:0xf bank_mask:0xf
    s_nop 0
    v_add_f32_dpp v56, v56, v56 quad_perm:[2,3,0,1] row_mask:0xf bank_mask:0xf
    v_add_f32_dpp v57, v57, v57 quad_perm:[2,3,0,1] row_mask:0xf bank_mask:0xf
    s_nop 0
    v_add_f32_dpp v56, v56, v56 row_half_mirror row_mask:0xf bank_mask:0xf
    v_add_f32_dpp v57, v57, v57 row_half_mirror row_mask:0xf bank_mask:0xf
    s_nop 0
    v_add_f32_dpp v56, v56, v56 row_mirror row_mask:0xf bank_mask:0xf
    v_add_f32_dpp v57, v57, v57 row_mirror row_mask:0xf bank_mask:0xf
    s_nop 0
    v_add_f32_dpp v56, v56, v56 row_bcast:15 row_mask:0xa bank_mask:0xf
    v_add_f32_dpp v57, v57, v57 row_bcast:15 row_mask:0xa bank_mask:0xf
    v_mul_f32 v56, 0xbb000000, v56
    v_mul_f32 v57, 0x3b000000, v57
    v_fma_f32 v57, -v56, v56, v57
    v_max_f32 v57, 0, v57
    v_cvt_pk_bf16_f32 v57, v57, v57
    v_lshlrev_b32 v57, 16, v57
    v_add_f32 v57, 0x3727c5ac, v57
    v_cvt_pk_bf16_f32 v57, v57, v57
    v_lshlrev_b32 v57, 16, v57
    v_sqrt_f32 v57, v57
    v_mov_b32 v58, 159744
    v_cvt_pk_bf16_f32 v56, v56, v57
L_tag:
    s_waitcnt vmcnt(0)
    v_readfirstlane_b32 s47, v3
    s_cmp_lg_u32 s47, 0
    s_cbranch_scc1 L_tag_ok
    buffer_load_dword v3, v2, s[56:59], 0 offen sc1
    s_sub_u32 s63, s63, 1
    s_cbranch_scc0 L_tag
    s_endpgm
L_tag_ok:
    v_mov_b32 v57, v3
    s_mov_b32 exec_lo, 0x10000
    s_mov_b32 exec_hi, 0x10000
    buffer_store_dwordx2 v[56:57], v7, s[28:31], s44 offen sc1
    ds_write_b32 v58, v3 offset:32
    s_mov_b64 exec, -1
    s_waitcnt lgkmcnt(0)
    s_barrier
    s_mov_b32 s46, 6
    s_cmp_lt_u32 s38, 24
    s_cbranch_scc1 L_loop_in
L_loop_v_in:
    ds_read_b64_tr_b16 v[48:49], v14 offset:4096
    ds_read_b64_tr_b16 v[50:51], v14 offset:4352
    ds_read_b64_tr_b16 v[52:53], v14 offset:6144
    ds_read_b64_tr_b16 v[54:55], v14 offset:6400
    ds_read_b64_tr_b16 v[56:57], v15 offset:4096
    ds_read_b128 v[16:19], v12 offset:0
    ds_read_b128 v[20:23], v13 offset:0
    ds_read_b64_tr_b16 v[58:59], v15 offset:4352
    ds_read_b64_tr_b16 v[60:61], v15 offset:6144
    ds_read_b64_tr_b16 v[62:63], v15 offset:6400
    ds_read_b128 v[24:27], v12 offset:2048
    ds_read_b128 v[28:31], v13 offset:2048
    ds_read_b128 v[32:35], v12 offset:4096
    ds_read_b128 v[36:39], v13 offset:4096
    ds_read_b128 v[40:43], v12 offset:6144
    ds_read_b128 v[44:47], v13 offset:6144
.p2align 6
L_loop_v:
    s_waitcnt lgkmcnt(6)
    v_mfma_f32_16x16x32_bf16 v[96:99], v[16:19], v[48:51], v[96:99]
    ds_read_b64_tr_b16 v[64:65], v14 offset:12288
    v_mfma_f32_16x16x32_bf16 v[96:99], v[20:23], v[52:55], v[96:99]
    ds_read_b64_tr_b16 v[66:67], v14 offset:12544
    v_mfma_f32_16x16x32_bf16 v[100:103], v[16:19], v[56:59], v[100:103]
    ds_read_b64_tr_b16 v[68:69], v14 offset:14336
    v_mfma_f32_16x16x32_bf16 v[100:103], v[20:23], v[60:63], v[100:103]
    ds_read_b64_tr_b16 v[70:71], v14 offset:14592
    s_waitcnt lgkmcnt(8)
    v_mfma_f32_16x16x32_bf16 v[104:107], v[24:27], v[48:51], v[104:107]
    ds_read_b64_tr_b16 v[72:73], v15 offset:12288
    v_mfma_f32_16x16x32_bf16 v[104:107], v[28:31], v[52:55], v[104:107]
    ds_read_b64_tr_b16 v[74:75], v15 offset:12544
    v_mfma_f32_16x16x32_bf16 v[108:111], v[24:27], v[56:59], v[108:111]
    ds_read_b64_tr_b16 v[76:77], v15 offset:14336
    v_mfma_f32_16x16x32_bf16 v[108:111], v[28:31], v[60:63], v[108:111]
    ds_read_b64_tr_b16 v[78:79], v15 offset:14592
    s_waitcnt lgkmcnt(10)
    v_mfma_f32_16x16x32_bf16 v[112:115], v[32:35], v[48:51], v[112:115]
    v_mfma_f32_16x16x32_bf16 v[112:115], v[36:39], v[52:55], v[112:115]
    v_mfma_f32_16x16x32_bf16 v[116:119], v[32:35], v[56:59], v[116:119]
    v_mfma_f32_16x16x32_bf16 v[116:119], v[36:39], v[60:63], v[116:119]
    s_waitcnt lgkmcnt(8)
    v_mfma_f32_16x16x32_bf16 v[120:123], v[40:43], v[48:51], v[120:123]
    v_mfma_f32_16x16x32_bf16 v[120:123], v[44:47], v[52:55], v[120:123]
    v_mfma_f32_16x16x32_bf16 v[124:127], v[40:43], v[56:59], v[124:127]
    v_mfma_f32_16x16x32_bf16 v[124:127], v[44:47], v[60:63], v[124:127]
    s_waitcnt lgkmcnt(0)
    v_mfma_f32_16x16x32_bf16 v[160:163], v[16:19], v[64:67], v[160:163]
    ds_read_b64_tr_b16 v[80:81], v14 offset:0
    v_mfma_f32_16x16x32_bf16 v[160:163], v[20:23], v[68:71], v[160:163]
    ds_read_b64_tr_b16 v[82:83], v14 offset:256
    v_mfma_f32_16x16x32_bf16 v[164:167], v[16:19], v[72:75], v[164:167]
    ds_read_b64_tr_b16 v[84:85], v14 offset:2048
    v_mfma_f32_16x16x32_bf16 v[164:167], v[20:23], v[76:79], v[164:167]
    ds_read_b64_tr_b16 v[86:87], v14 offset:2304
    v_mfma_f32_16x16x32_bf16 v[168:171], v[24:27], v[64:67], v[168:171]
    ds_read_b64_tr_b16 v[48:49], v15 offset:0
    v_mfma_f32_16x16x32_bf16 v[168:171], v[28:31], v[68:71], v[168:171]
    ds_read_b64_tr_b16 v[50:51], v15 offset:256
    v_mfma_f32_16x16x32_bf16 v[172:175], v[24:27], v[72:75], v[172:175]
    ds_read_b64_tr_b16 v[52:53], v15 offset:2048
    v_mfma_f32_16x16x32_bf16 v[172:175], v[28:31], v[76:79], v[172:175]
    ds_read_b64_tr_b16 v[54:55], v15 offset:2304
    v_mfma_f32_16x16x32_bf16 v[176:179], v[32:35], v[64:67], v[176:179]
    v_mfma_f32_16x16x32_bf16 v[176:179], v[36:39], v[68:71], v[176:179]
    v_mfma_f32_16x16x32_bf16 v[180:183], v[32:35], v[72:75], v[180:183]
    v_mfma_f32_16x16x32_bf16 v[180:183], v[36:39], v[76:79], v[180:183]
    v_mfma_f32_16x16x32_bf16 v[184:187], v[40:43], v[64:67], v[184:187]
    v_mfma_f32_16x16x32_bf16 v[184:187], v[44:47], v[68:71], v[184:187]
    v_mfma_f32_16x16x32_bf16 v[188:191], v[40:43], v[72:75], v[188:191]
    v_mfma_f32_16x16x32_bf16 v[188:191], v[44:47], v[76:79], v[188:191]
    s_waitcnt lgkmcnt(0)
    v_mfma_f32_16x16x32_bf16 v[192:195], v[80:83], v[16:19], v[192:195]
    ds_read_b64_tr_b16 v[56:57], v14 offset:8192
    v_mfma_f32_16x16x32_bf16 v[192:195], v[84:87], v[20:23], v[192:195]
    ds_read_b64_tr_b16 v[58:59], v14 offset:8448
    v_mfma_f32_16x16x32_bf16 v[196:199], v[48:51], v[16:19], v[196:199]
    ds_read_b64_tr_b16 v[60:61], v14 offset:10240
    v_mfma_f32_16x16x32_bf16 v[196:199], v[52:55], v[20:23], v[196:199]
    ds_read_b64_tr_b16 v[62:63], v14 offset:10496
    v_mfma_f32_16x16x32_bf16 v[200:203], v[80:83], v[24:27], v[200:203]
    ds_read_b64_tr_b16 v[64:65], v15 offset:8192
    v_mfma_f32_16x16x32_bf16 v[200:203], v[84:87], v[28:31], v[200:203]
    ds_read_b64_tr_b16 v[66:67], v15 offset:8448
    v_mfma_f32_16x16x32_bf16 v[204:207], v[48:51], v[24:27], v[204:207]
    ds_read_b64_tr_b16 v[68:69], v15 offset:10240
    v_mfma_f32_16x16x32_bf16 v[204:207], v[52:55], v[28:31], v[204:207]
    ds_read_b64_tr_b16 v[70:71], v15 offset:10496
    v_mfma_f32_16x16x32_bf16 v[208:211], v[80:83], v[32:35], v[208:211]
    v_mfma_f32_16x16x32_bf16 v[208:211], v[84:87], v[36:39], v[208:211]
    v_mfma_f32_16x16x32_bf16 v[212:215], v[48:51], v[32:35], v[212:215]
    v_mfma_f32_16x16x32_bf16 v[212:215], v[52:55], v[36:39], v[212:215]
    v_mfma_f32_16x16x32_bf16 v[216:219], v[80:83], v[40:43], v[216:219]
    v_mfma_f32_16x16x32_bf16 v[216:219], v[84:87], v[44:47], v[216:219]
    v_mfma_f32_16x16x32_bf16 v[220:223], v[48:51], v[40:43], v[220:223]
    v_mfma_f32_16x16x32_bf16 v[220:223], v[52:55], v[44:47], v[220:223]
    s_waitcnt lgkmcnt(0)
    v_mfma_f32_16x16x32_bf16 v[128:131], v[56:59], v[16:19], v[128:131]
    ds_read_b64_tr_b16 v[72:73], v14 offset:16384
    v_mfma_f32_16x16x32_bf16 v[128:131], v[60:63], v[20:23], v[128:131]
    ds_read_b64_tr_b16 v[74:75], v14 offset:16640
    v_mfma_f32_16x16x32_bf16 v[132:135], v[64:67], v[16:19], v[132:135]
    ds_read_b64_tr_b16 v[76:77], v14 offset:18432
    v_mfma_f32_16x16x32_bf16 v[132:135], v[68:71], v[20:23], v[132:135]
    ds_read_b64_tr_b16 v[78:79], v14 offset:18688
    v_mfma_f32_16x16x32_bf16 v[136:139], v[56:59], v[24:27], v[136:139]
    ds_read_b64_tr_b16 v[80:81], v15 offset:16384
    v_mfma_f32_16x16x32_bf16 v[136:139], v[60:63], v[28:31], v[136:139]
    ds_read_b64_tr_b16 v[82:83], v15 offset:16640
    v_mfma_f32_16x16x32_bf16 v[140:143], v[64:67], v[24:27], v[140:143]
    ds_read_b64_tr_b16 v[84:85], v15 offset:18432
    v_mfma_f32_16x16x32_bf16 v[140:143], v[68:71], v[28:31], v[140:143]
    ds_read_b64_tr_b16 v[86:87], v15 offset:18688
    v_mfma_f32_16x16x32_bf16 v[144:147], v[56:59], v[32:35], v[144:147]
    s_add_u32 s45, s45, 53248
    v_mfma_f32_16x16x32_bf16 v[144:147], v[60:63], v[36:39], v[144:147]
    s_cmp_eq_u32 s45, 159744
    v_mfma_f32_16x16x32_bf16 v[148:151], v[64:67], v[32:35], v[148:151]
    s_cselect_b32 s45, 0, s45
    v_mfma_f32_16x16x32_bf16 v[148:151], v[68:71], v[36:39], v[148:151]
    v_add_u32 v12, s45, v10
    v_mfma_f32_16x16x32_bf16 v[152:155], v[56:59], v[40:43], v[152:155]
    v_add_u32 v14, s45, v11
    v_mfma_f32_16x16x32_bf16 v[152:155], v[60:63], v[44:47], v[152:155]
    v_xor_b32 v13, 64, v12
    v_mfma_f32_16x16x32_bf16 v[156:159], v[64:67], v[40:43], v[156:159]
    v_xor_b32 v15, 16, v14
    v_mfma_f32_16x16x32_bf16 v[156:159], v[68:71], v[44:47], v[156:159]
    s_waitcnt lgkmcnt(0)
    v_mfma_f32_16x16x32_bf16 v[224:227], v[72:75], v[16:19], v[224:227]
    s_barrier
    ds_read_b64_tr_b16 v[48:49], v14 offset:4096
    v_mfma_f32_16x16x32_bf16 v[224:227], v[76:79], v[20:23], v[224:227]
    ds_read_b64_tr_b16 v[50:51], v14 offset:4352
    ds_read_b64_tr_b16 v[52:53], v14 offset:6144
    v_mfma_f32_16x16x32_bf16 v[228:231], v[80:83], v[16:19], v[228:231]
    ds_read_b64_tr_b16 v[54:55], v14 offset:6400
    ds_read_b64_tr_b16 v[56:57], v15 offset:4096
    v_mfma_f32_16x16x32_bf16 v[228:231], v[84:87], v[20:23], v[228:231]
    ds_read_b128 v[16:19], v12 offset:0
    v_mfma_f32_16x16x32_bf16 v[232:235], v[72:75], v[24:27], v[232:235]
    ds_read_b128 v[20:23], v13 offset:0
    v_mfma_f32_16x16x32_bf16 v[232:235], v[76:79], v[28:31], v[232:235]
    ds_read_b64_tr_b16 v[58:59], v15 offset:4352
    ds_read_b64_tr_b16 v[60:61], v15 offset:6144
    v_mfma_f32_16x16x32_bf16 v[236:239], v[80:83], v[24:27], v[236:239]
    ds_read_b64_tr_b16 v[62:63], v15 offset:6400
    v_mfma_f32_16x16x32_bf16 v[236:239], v[84:87], v[28:31], v[236:239]
    ds_read_b128 v[24:27], v12 offset:2048
    v_mfma_f32_16x16x32_bf16 v[240:243], v[72:75], v[32:35], v[240:243]
    ds_read_b128 v[28:31], v13 offset:2048
    v_mfma_f32_16x16x32_bf16 v[240:243], v[76:79], v[36:39], v[240:243]
    v_mfma_f32_16x16x32_bf16 v[244:247], v[80:83], v[32:35], v[244:247]
    v_mfma_f32_16x16x32_bf16 v[244:247], v[84:87], v[36:39], v[244:247]
    ds_read_b128 v[32:35], v12 offset:4096
    v_mfma_f32_16x16x32_bf16 v[248:251], v[72:75], v[40:43], v[248:251]
    s_sub_u32 s46, s46, 1
    ds_read_b128 v[36:39], v13 offset:4096
    v_mfma_f32_16x16x32_bf16 v[248:251], v[76:79], v[44:47], v[248:251]
    v_mfma_f32_16x16x32_bf16 v[252:255], v[80:83], v[40:43], v[252:255]
    v_mfma_f32_16x16x32_bf16 v[252:255], v[84:87], v[44:47], v[252:255]
    ds_read_b128 v[40:43], v12 offset:6144
    ds_read_b128 v[44:47], v13 offset:6144
    s_cbranch_scc0 L_loop_v
    s_waitcnt lgkmcnt(6)
    v_mfma_f32_16x16x32_bf16 v[96:99], v[16:19], v[48:51], v[96:99]
    v_and_b32 v7, 15, v1
    v_lshrrev_b32 v6, 4, v1
    v_mfma_f32_16x16x32_bf16 v[96:99], v[20:23], v[52:55], v[96:99]
    s_lshl_b32 s47, s36, 10
    s_add_u32 s47, s47, 111616
    s_waitcnt lgkmcnt(4)
    v_mfma_f32_16x16x32_bf16 v[104:107], v[24:27], v[48:51], v[104:107]
    v_lshl_add_u32 v11, v7, 4, s47
    v_lshlrev_b32 v10, 5, v7
    v_mfma_f32_16x16x32_bf16 v[104:107], v[28:31], v[52:55], v[104:107]
    v_lshl_add_u32 v10, v6, 3, v10
    v_add_u32 v10, 106496, v10
    s_waitcnt lgkmcnt(2)
    v_mfma_f32_16x16x32_bf16 v[112:115], v[32:35], v[48:51], v[112:115]
    ds_read_b64 v[72:73], v11 offset:0
    s_lshl_b32 s47, s36, 8
    v_mfma_f32_16x16x32_bf16 v[112:115], v[36:39], v[52:55], v[112:115]
    ds_read_b64 v[74:75], v11 offset:256
    s_add_u32 s47, s47, 115712
    s_waitcnt lgkmcnt(2)
    v_mfma_f32_16x16x32_bf16 v[120:123], v[40:43], v[48:51], v[120:123]
    ds_read_b64 v[76:77], v11 offset:512
    v_lshl_add_u32 v12, v7, 2, s47
    v_mfma_f32_16x16x32_bf16 v[120:123], v[44:47], v[52:55], v[120:123]
    ds_read_b64 v[78:79], v11 offset:768
    v_lshl_add_u32 v13, v6, 4, s47
    v_mfma_f32_16x16x32_bf16 v[100:103], v[16:19], v[56:59], v[100:103]
    ds_read_b64 v[80:81], v10 offset:1024
    s_lshl_b32 s41, s37, 2
    v_mfma_f32_16x16x32_bf16 v[100:103], v[20:23], v[60:63], v[100:103]
    ds_read_b64 v[82:83], v10 offset:1536
    s_add_u32 s41, s41, s36
    v_mfma_f32_16x16x32_bf16 v[108:111], v[24:27], v[56:59], v[108:111]
    ds_read_b64_tr_b16 v[64:65], v14 offset:12288
    s_lshl_b32 s39, s41, 16
    v_mfma_f32_16x16x32_bf16 v[108:111], v[28:31], v[60:63], v[108:111]
    ds_read_b64_tr_b16 v[66:67], v14 offset:12544
    s_lshl_b32 s48, s38, 10
    v_mfma_f32_16x16x32_bf16 v[116:119], v[32:35], v[56:59], v[116:119]
    ds_read_b64_tr_b16 v[68:69], v14 offset:14336
    s_add_u32 s39, s39, s48
    v_mfma_f32_16x16x32_bf16 v[116:119], v[36:39], v[60:63], v[116:119]
    ds_read_b64_tr_b16 v[70:71], v14 offset:14592
    s_add_u32 s39, s39, 6291456
    v_mfma_f32_16x16x32_bf16 v[124:127], v[40:43], v[56:59], v[124:127]
    s_add_u32 s40, s39, 0x8000
    s_lshl_b32 s41, s41, 11
    v_mfma_f32_16x16x32_bf16 v[124:127], v[44:47], v[60:63], v[124:127]
    s_lshl_b32 s44, s38, 16
    s_add_u32 s44, s44, s41
    s_waitcnt lgkmcnt(6)
    s_waitcnt lgkmcnt(5)
    v_mfma_f32_16x16x16_bf16 v[96:99], v[72:73], v[80:81], v[96:99]
    ds_read_b64_tr_b16 v[48:49], v15 offset:12288
    s_add_u32 s44, s44, 2097152
    v_mfma_f32_16x16x16_bf16 v[104:107], v[74:75], v[80:81], v[104:107]
    ds_read_b64_tr_b16 v[50:51], v15 offset:12544
    s_lshl_b32 s48, s36, 12
    v_mfma_f32_16x16x16_bf16 v[112:115], v[76:77], v[80:81], v[112:115]
    ds_read_b64_tr_b16 v[52:53], v15 offset:14336
    s_add_u32 s48, s48, 32768
    v_mfma_f32_16x16x16_bf16 v[120:123], v[78:79], v[80:81], v[120:123]
    ds_read_b64_tr_b16 v[54:55], v15 offset:14592
    v_add_u32 v9, s48, v4
    s_waitcnt lgkmcnt(8)
    v_mfma_f32_16x16x16_bf16 v[100:103], v[72:73], v[82:83], v[100:103]
    s_lshl_b32 s48, s36, 11
    s_add_u32 s48, s48, 0
    v_mfma_f32_16x16x16_bf16 v[108:111], v[74:75], v[82:83], v[108:111]
    v_lshl_add_u32 v5, v7, 4, s48
    v_lshl_add_u32 v5, v6, 9, v5
    v_mfma_f32_16x16x16_bf16 v[116:119], v[76:77], v[82:83], v[116:119]
    v_and_b32 v6, 7, v1
    v_lshlrev_b32 v6, 4, v6
    v_mfma_f32_16x16x16_bf16 v[124:127], v[78:79], v[82:83], v[124:127]
    v_and_b32 v7, 8, v1
    v_lshl_add_u32 v6, v7, 13, v6
    s_waitcnt lgkmcnt(4)
    v_mfma_f32_16x16x32_bf16 v[160:163], v[16:19], v[64:67], v[160:163]
    v_and_b32 v7, 16, v1
    v_lshl_add_u32 v6, v7, 5, v6
    v_mfma_f32_16x16x32_bf16 v[160:163], v[20:23], v[68:71], v[160:163]
    v_and_b32 v7, 32, v1
    v_lshl_add_u32 v6, v7, 3, v6
    v_mfma_f32_16x16x32_bf16 v[168:171], v[24:27], v[64:67], v[168:171]
    ds_read_b64 v[80:81], v10 offset:3072
    s_lshl_b32 s42, s38, 18
    v_mfma_f32_16x16x32_bf16 v[168:171], v[28:31], v[68:71], v[168:171]
    ds_read_b64 v[82:83], v10 offset:3584
    s_add_u32 s42, s42, s41
    v_mfma_f32_16x16x32_bf16 v[176:179], v[32:35], v[64:67], v[176:179]
    s_add_u32 s42, s42, 4292870144
    s_add_u32 s43, s42, 0x20000
    v_mfma_f32_16x16x32_bf16 v[176:179], v[36:39], v[68:71], v[176:179]
    ds_read_b128 v[88:91], v13 offset:0
    ds_read_b128 v[92:95], v13 offset:64
    v_mfma_f32_16x16x32_bf16 v[184:187], v[40:43], v[64:67], v[184:187]
    ds_read_b32 v84, v12 offset:0
    ds_read_b32 v85, v12 offset:64
    v_mfma_f32_16x16x32_bf16 v[184:187], v[44:47], v[68:71], v[184:187]
    ds_read_b32 v86, v12 offset:128
    ds_read_b32 v87, v12 offset:192
    s_waitcnt lgkmcnt(8)
    v_mfma_f32_16x16x32_bf16 v[164:167], v[16:19], v[48:51], v[164:167]
    s_waitcnt lgkmcnt(4)
    v_mul_f32 v96, v88, v96
    v_mul_f32 v97, v89, v97
    v_mul_f32 v98, v90, v98
    v_mfma_f32_16x16x32_bf16 v[164:167], v[20:23], v[52:55], v[164:167]
    v_mul_f32 v99, v91, v99
    v_mul_f32 v100, v88, v100
    v_mul_f32 v101, v89, v101
    v_mul_f32 v102, v90, v102
    v_mfma_f32_16x16x32_bf16 v[172:175], v[24:27], v[48:51], v[172:175]
    ds_read_b64_tr_b16 v[56:57], v14 offset:0
    v_mul_f32 v103, v91, v103
    v_mul_f32 v104, v92, v104
    v_mul_f32 v105, v93, v105
    v_mfma_f32_16x16x32_bf16 v[172:175], v[28:31], v[52:55], v[172:175]
    ds_read_b64_tr_b16 v[58:59], v14 offset:256
    v_mul_f32 v106, v94, v106
    v_mul_f32 v107, v95, v107
    v_mul_f32 v108, v92, v108
    v_mfma_f32_16x16x32_bf16 v[180:183], v[32:35], v[48:51], v[180:183]
    ds_read_b64_tr_b16 v[60:61], v14 offset:2048
    v_mul_f32 v109, v93, v109
    v_mul_f32 v110, v94, v110
    v_mul_f32 v111, v95, v111
    v_mfma_f32_16x16x32_bf16 v[180:183], v[36:39], v[52:55], v[180:183]
    ds_read_b64_tr_b16 v[62:63], v14 offset:2304
    ds_read_b128 v[88:91], v13 offset:128
    ds_read_b128 v[92:95], v13 offset:192
    v_cvt_pk_bf16_f32 v96, v96, v97
    v_mfma_f32_16x16x32_bf16 v[188:191], v[40:43], v[48:51], v[188:191]
    v_cvt_pk_bf16_f32 v97, v98, v99
    v_cvt_pk_bf16_f32 v98, v104, v105
    v_cvt_pk_bf16_f32 v99, v106, v107
    v_cvt_pk_bf16_f32 v100, v100, v101
    v_mfma_f32_16x16x32_bf16 v[188:191], v[44:47], v[52:55], v[188:191]
    v_cvt_pk_bf16_f32 v101, v102, v103
    v_cvt_pk_bf16_f32 v102, v108, v109
    v_cvt_pk_bf16_f32 v103, v110, v111
    v_permlane32_swap_b32 v96, v98
    v_mfma_f32_16x16x16_bf16 v[160:163], v[72:73], v[80:81], v[160:163]
    ds_read_b64_tr_b16 v[64:65], v15 offset:0
    v_permlane32_swap_b32 v97, v99
    v_permlane32_swap_b32 v100, v102
    v_mfma_f32_16x16x16_bf16 v[168:171], v[74:75], v[80:81], v[168:171]
    ds_read_b64_tr_b16 v[66:67], v15 offset:256
    v_permlane32_swap_b32 v101, v103
    v_mfma_f32_16x16x16_bf16 v[176:179], v[76:77], v[80:81], v[176:179]
    ds_read_b64_tr_b16 v[68:69], v15 offset:2048
    buffer_store_dwordx4 v[96:99], v6, s[28:31], s42 offen offset:0 sc1
    buffer_store_dwordx4 v[100:103], v6, s[28:31], s42 offen offset:128 sc1
    v_mfma_f32_16x16x16_bf16 v[184:187], v[78:79], v[80:81], v[184:187]
    ds_read_b64_tr_b16 v[70:71], v15 offset:2304
    s_waitcnt lgkmcnt(4)
    v_mul_f32 v112, v88, v112
    v_mul_f32 v113, v89, v113
    v_mfma_f32_16x16x16_bf16 v[164:167], v[72:73], v[82:83], v[164:167]
    v_mul_f32 v114, v90, v114
    v_mul_f32 v115, v91, v115
    v_mul_f32 v116, v88, v116
    v_mul_f32 v117, v89, v117
    v_mfma_f32_16x16x16_bf16 v[172:175], v[74:75], v[82:83], v[172:175]
    v_mul_f32 v118, v90, v118
    v_mul_f32 v119, v91, v119
    v_mul_f32 v120, v92, v120
    v_mul_f32 v121, v93, v121
    v_mfma_f32_16x16x16_bf16 v[180:183], v[76:77], v[82:83], v[180:183]
    v_mul_f32 v122, v94, v122
    v_mul_f32 v123, v95, v123
    v_mul_f32 v124, v92, v124
    v_mul_f32 v125, v93, v125
    v_mfma_f32_16x16x16_bf16 v[188:191], v[78:79], v[82:83], v[188:191]
    v_mul_f32 v126, v94, v126
    v_mul_f32 v127, v95, v127
    v_mfma_f32_16x16x32_bf16 v[192:195], v[56:59], v[16:19], v[192:195]
    ds_read_b128 v[88:91], v13 offset:0
    ds_read_b128 v[92:95], v13 offset:64
    v_cvt_pk_bf16_f32 v112, v112, v113
    v_cvt_pk_bf16_f32 v113, v114, v115
    v_mfma_f32_16x16x32_bf16 v[192:195], v[60:63], v[20:23], v[192:195]
    v_cvt_pk_bf16_f32 v114, v120, v121
    v_cvt_pk_bf16_f32 v115, v122, v123
    v_cvt_pk_bf16_f32 v116, v116, v117
    v_cvt_pk_bf16_f32 v117, v118, v119
    v_mfma_f32_16x16x32_bf16 v[200:203], v[56:59], v[24:27], v[200:203]
    ds_read_b64 v[80:81], v10 offset:0
    v_cvt_pk_bf16_f32 v118, v124, v125
    v_cvt_pk_bf16_f32 v119, v126, v127
    v_permlane32_swap_b32 v112, v114
    v_mfma_f32_16x16x32_bf16 v[200:203], v[60:63], v[28:31], v[200:203]
    ds_read_b64 v[82:83], v10 offset:512
    v_permlane32_swap_b32 v113, v115
    v_permlane32_swap_b32 v116, v118
    v_mfma_f32_16x16x32_bf16 v[208:211], v[56:59], v[32:35], v[208:211]
    v_permlane32_swap_b32 v117, v119
    v_mfma_f32_16x16x32_bf16 v[208:211], v[60:63], v[36:39], v[208:211]
    buffer_store_dwordx4 v[112:115], v6, s[28:31], s42 offen offset:1024 sc1
    buffer_store_dwordx4 v[116:119], v6, s[28:31], s42 offen offset:1152 sc1
    v_mfma_f32_16x16x32_bf16 v[216:219], v[56:59], v[40:43], v[216:219]
    s_waitcnt lgkmcnt(2)
    v_mul_f32 v160, v88, v160
    v_mul_f32 v161, v89, v161
    v_mul_f32 v162, v90, v162
    v_mfma_f32_16x16x32_bf16 v[216:219], v[60:63], v[44:47], v[216:219]
    v_mul_f32 v163, v91, v163
    v_mul_f32 v164, v88, v164
    v_mul_f32 v165, v89, v165
    v_mul_f32 v166, v90, v166
    v_mfma_f32_16x16x32_bf16 v[196:199], v[64:67], v[16:19], v[196:199]
    v_mul_f32 v167, v91, v167
    v_mul_f32 v168, v92, v168
    v_mul_f32 v169, v93, v169
    v_mul_f32 v170, v94, v170
    v_mfma_f32_16x16x32_bf16 v[196:199], v[68:71], v[20:23], v[196:199]
    v_mul_f32 v171, v95, v171
    v_mul_f32 v172, v92, v172
    v_mul_f32 v173, v93, v173
    v_mul_f32 v174, v94, v174
    v_mfma_f32_16x16x32_bf16 v[204:207], v[64:67], v[24:27], v[204:207]
    ds_read_b64_tr_b16 v[48:49], v14 offset:8192
    v_mul_f32 v175, v95, v175
    v_mfma_f32_16x16x32_bf16 v[204:207], v[68:71], v[28:31], v[204:207]
    ds_read_b64_tr_b16 v[50:51], v14 offset:8448
    ds_read_b128 v[88:91], v13 offset:128
    ds_read_b128 v[92:95], v13 offset:192
    v_cvt_pk_bf16_f32 v160, v160, v161
    v_mfma_f32_16x16x32_bf16 v[212:215], v[64:67], v[32:35], v[212:215]
    ds_read_b64_tr_b16 v[52:53], v14 offset:10240
    v_cvt_pk_bf16_f32 v161, v162, v163
    v_cvt_pk_bf16_f32 v162, v168, v169
    v_cvt_pk_bf16_f32 v163, v170, v171
    v_mfma_f32_16x16x32_bf16 v[212:215], v[68:71], v[36:39], v[212:215]
    ds_read_b64_tr_b16 v[54:55], v14 offset:10496
    v_cvt_pk_bf16_f32 v164, v164, v165
    v_cvt_pk_bf16_f32 v165, v166, v167
    v_cvt_pk_bf16_f32 v166, v172, v173
    v_mfma_f32_16x16x32_bf16 v[220:223], v[64:67], v[40:43], v[220:223]
    v_cvt_pk_bf16_f32 v167, v174, v175
    v_permlane32_swap_b32 v160, v162
    v_permlane32_swap_b32 v161, v163
    v_mfma_f32_16x16x32_bf16 v[220:223], v[68:71], v[44:47], v[220:223]
    v_permlane32_swap_b32 v164, v166
    v_permlane32_swap_b32 v165, v167
    s_waitcnt lgkmcnt(7)
    v_mfma_f32_16x16x16_bf16 v[192:195], v[80:81], v[72:73], v[192:195]
    ds_read_b64_tr_b16 v[56:57], v15 offset:8192
    buffer_store_dwordx4 v[160:163], v6, s[28:31], s43 offen offset:0 sc1
    buffer_store_dwordx4 v[164:167], v6, s[28:31], s43 offen offset:128 sc1
    v_mfma_f32_16x16x16_bf16 v[200:203], v[80:81], v[74:75], v[200:203]
    ds_read_b64_tr_b16 v[58:59], v15 offset:8448
    s_waitcnt lgkmcnt(4)
    v_mul_f32 v176, v88, v176
    v_mul_f32 v177, v89, v177
    v_mfma_f32_16x16x16_bf16 v[208:211], v[80:81], v[76:77], v[208:211]
    ds_read_b64_tr_b16 v[60:61], v15 offset:10240
    v_mul_f32 v178, v90, v178
    v_mul_f32 v179, v91, v179
    v_mul_f32 v180, v88, v180
    v_mfma_f32_16x16x16_bf16 v[216:219], v[80:81], v[78:79], v[216:219]
    ds_read_b64_tr_b16 v[62:63], v15 offset:10496
    v_mul_f32 v181, v89, v181
    v_mul_f32 v182, v90, v182
    v_mul_f32 v183, v91, v183
    v_mfma_f32_16x16x16_bf16 v[196:199], v[82:83], v[72:73], v[196:199]
    v_mul_f32 v184, v92, v184
    v_mul_f32 v185, v93, v185
    v_mul_f32 v186, v94, v186
    v_mul_f32 v187, v95, v187
    v_mfma_f32_16x16x16_bf16 v[204:207], v[82:83], v[74:75], v[204:207]
    v_mul_f32 v188, v92, v188
    v_mul_f32 v189, v93, v189
    v_mul_f32 v190, v94, v190
    v_mul_f32 v191, v95, v191
    v_mfma_f32_16x16x16_bf16 v[212:215], v[82:83], v[76:77], v[212:215]
    v_cvt_pk_bf16_f32 v176, v176, v177
    v_cvt_pk_bf16_f32 v177, v178, v179
    v_cvt_pk_bf16_f32 v178, v184, v185
    v_cvt_pk_bf16_f32 v179, v186, v187
    v_mfma_f32_16x16x16_bf16 v[220:223], v[82:83], v[78:79], v[220:223]
    v_cvt_pk_bf16_f32 v180, v180, v181
    v_cvt_pk_bf16_f32 v181, v182, v183
    v_cvt_pk_bf16_f32 v182, v188, v189
    v_cvt_pk_bf16_f32 v183, v190, v191
    s_waitcnt lgkmcnt(4)
    v_mfma_f32_16x16x32_bf16 v[128:131], v[48:51], v[16:19], v[128:131]
    v_permlane32_swap_b32 v176, v178
    v_permlane32_swap_b32 v177, v179
    v_mfma_f32_16x16x32_bf16 v[128:131], v[52:55], v[20:23], v[128:131]
    v_permlane32_swap_b32 v180, v182
    v_permlane32_swap_b32 v181, v183
    v_mfma_f32_16x16x32_bf16 v[136:139], v[48:51], v[24:27], v[136:139]
    ds_read_b64 v[80:81], v10 offset:2048
    buffer_store_dwordx4 v[176:179], v6, s[28:31], s43 offen offset:1024 sc1
    buffer_store_dwordx4 v[180:183], v6, s[28:31], s43 offen offset:1152 sc1
    v_mfma_f32_16x16x32_bf16 v[136:139], v[52:55], v[28:31], v[136:139]
    ds_read_b64 v[82:83], v10 offset:2560
    v_mfma_f32_16x16x32_bf16 v[144:147], v[48:51], v[32:35], v[144:147]
    s_mov_b32 exec_hi, 0
    v_mul_f32 v84, 0x3eb8aa3b, v84
    v_mul_f32 v85, 0x3eb8aa3b, v85
    v_mul_f32 v86, 0x3eb8aa3b, v86
    v_mul_f32 v87, 0x3eb8aa3b, v87
    s_mov_b32 exec_hi, -1
    v_mfma_f32_16x16x32_bf16 v[144:147], v[52:55], v[36:39], v[144:147]
    v_mul_f32 v192, v84, v192
    v_mul_f32 v193, v84, v193
    v_mfma_f32_16x16x32_bf16 v[152:155], v[48:51], v[40:43], v[152:155]
    v_mul_f32 v194, v84, v194
    v_mul_f32 v195, v84, v195
    v_mfma_f32_16x16x32_bf16 v[152:155], v[52:55], v[44:47], v[152:155]
    v_mul_f32 v196, v84, v196
    v_mul_f32 v197, v84, v197
    s_waitcnt lgkmcnt(2)
    v_mfma_f32_16x16x32_bf16 v[132:135], v[56:59], v[16:19], v[132:135]
    v_mul_f32 v198, v84, v198
    v_mul_f32 v199, v84, v199
    v_mfma_f32_16x16x32_bf16 v[132:135], v[60:63], v[20:23], v[132:135]
    v_mul_f32 v200, v85, v200
    v_mul_f32 v201, v85, v201
    v_mfma_f32_16x16x32_bf16 v[140:143], v[56:59], v[24:27], v[140:143]
    ds_read_b64_tr_b16 v[64:65], v14 offset:16384
    v_mul_f32 v202, v85, v202
    v_mfma_f32_16x16x32_bf16 v[140:143], v[60:63], v[28:31], v[140:143]
    ds_read_b64_tr_b16 v[66:67], v14 offset:16640
    v_mul_f32 v203, v85, v203
    v_mfma_f32_16x16x32_bf16 v[148:151], v[56:59], v[32:35], v[148:151]
    ds_read_b64_tr_b16 v[68:69], v14 offset:18432
    v_mul_f32 v204, v85, v204
    v_mfma_f32_16x16x32_bf16 v[148:151], v[60:63], v[36:39], v[148:151]
    ds_read_b64_tr_b16 v[70:71], v14 offset:18688
    v_mul_f32 v205, v85, v205
    v_mfma_f32_16x16x32_bf16 v[156:159], v[56:59], v[40:43], v[156:159]
    v_mul_f32 v206, v85, v206
    v_mul_f32 v207, v85, v207
    v_mfma_f32_16x16x32_bf16 v[156:159], v[60:63], v[44:47], v[156:159]
    v_cvt_pk_bf16_f32 v192, v192, v193
    v_cvt_pk_bf16_f32 v193, v194, v195
    s_waitcnt lgkmcnt(5)
    v_mfma_f32_16x16x16_bf16 v[128:131], v[80:81], v[72:73], v[128:131]
    ds_read_b64_tr_b16 v[48:49], v15 offset:16384
    v_cvt_pk_bf16_f32 v194, v196, v197
    v_mfma_f32_16x16x16_bf16 v[136:139], v[80:81], v[74:75], v[136:139]
    ds_read_b64_tr_b16 v[50:51], v15 offset:16640
    v_cvt_pk_bf16_f32 v195, v198, v199
    v_mfma_f32_16x16x16_bf16 v[144:147], v[80:81], v[76:77], v[144:147]
    ds_read_b64_tr_b16 v[52:53], v15 offset:18432
    v_cvt_pk_bf16_f32 v196, v200, v201
    v_mfma_f32_16x16x16_bf16 v[152:155], v[80:81], v[78:79], v[152:155]
    ds_read_b64_tr_b16 v[54:55], v15 offset:18688
    v_cvt_pk_bf16_f32 v197, v202, v203
    s_waitcnt lgkmcnt(8)
    v_mfma_f32_16x16x16_bf16 v[132:135], v[82:83], v[72:73], v[132:135]
    v_cvt_pk_bf16_f32 v198, v204, v205
    v_cvt_pk_bf16_f32 v199, v206, v207
    v_mfma_f32_16x16x16_bf16 v[140:143], v[82:83], v[74:75], v[140:143]
    v_permlane16_swap_b32 v192, v196
    v_mfma_f32_16x16x16_bf16 v[148:151], v[82:83], v[76:77], v[148:151]
    v_permlane16_swap_b32 v193, v197
    v_mfma_f32_16x16x16_bf16 v[156:159], v[82:83], v[78:79], v[156:159]
    v_permlane16_swap_b32 v194, v198
    s_waitcnt lgkmcnt(4)
    v_mfma_f32_16x16x32_bf16 v[224:227], v[64:67], v[16:19], v[224:227]
    v_permlane16_swap_b32 v195, v199
    v_mfma_f32_16x16x32_bf16 v[224:227], v[68:71], v[20:23], v[224:227]
    v_permlane32_swap_b32 v192, v196
    v_mfma_f32_16x16x32_bf16 v[232:235], v[64:67], v[24:27], v[232:235]
    ds_read_b64 v[80:81], v10 offset:4096
    v_permlane32_swap_b32 v193, v197
    v_mfma_f32_16x16x32_bf16 v[232:235], v[68:71], v[28:31], v[232:235]
    ds_read_b64 v[82:83], v10 offset:4608
    v_permlane32_swap_b32 v194, v198
    v_mfma_f32_16x16x32_bf16 v[240:243], v[64:67], v[32:35], v[240:243]
    v_permlane32_swap_b32 v195, v199
    v_mfma_f32_16x16x32_bf16 v[240:243], v[68:71], v[36:39], v[240:243]
    ds_write_b128 v9, v[196:199] offset:0
    v_mul_f32 v208, v86, v208
    v_mfma_f32_16x16x32_bf16 v[248:251], v[64:67], v[40:43], v[248:251]
    v_mul_f32 v209, v86, v209
    v_mul_f32 v210, v86, v210
    v_mfma_f32_16x16x32_bf16 v[248:251], v[68:71], v[44:47], v[248:251]
    v_mul_f32 v211, v86, v211
    v_mul_f32 v212, v86, v212
    s_waitcnt lgkmcnt(3)
    v_mfma_f32_16x16x32_bf16 v[228:231], v[48:51], v[16:19], v[228:231]
    v_mul_f32 v213, v86, v213
    v_mul_f32 v214, v86, v214
    v_mfma_f32_16x16x32_bf16 v[228:231], v[52:55], v[20:23], v[228:231]
    v_mul_f32 v215, v86, v215
    v_mul_f32 v216, v87, v216
    v_mfma_f32_16x16x32_bf16 v[236:239], v[48:51], v[24:27], v[236:239]
    v_mul_f32 v217, v87, v217
    v_mul_f32 v218, v87, v218
    v_mfma_f32_16x16x32_bf16 v[236:239], v[52:55], v[28:31], v[236:239]
    v_mul_f32 v219, v87, v219
    v_mul_f32 v220, v87, v220
    v_mfma_f32_16x16x32_bf16 v[244:247], v[48:51], v[32:35], v[244:247]
    v_mul_f32 v221, v87, v221
    v_mul_f32 v222, v87, v222
    v_mfma_f32_16x16x32_bf16 v[244:247], v[52:55], v[36:39], v[244:247]
    v_mul_f32 v223, v87, v223
    v_cvt_pk_bf16_f32 v208, v208, v209
    v_mfma_f32_16x16x32_bf16 v[252:255], v[48:51], v[40:43], v[252:255]
    v_cvt_pk_bf16_f32 v209, v210, v211
    v_cvt_pk_bf16_f32 v210, v212, v213
    v_mfma_f32_16x16x32_bf16 v[252:255], v[52:55], v[44:47], v[252:255]
    v_cvt_pk_bf16_f32 v211, v214, v215
    v_cvt_pk_bf16_f32 v212, v216, v217
    s_waitcnt lgkmcnt(2)
    v_mfma_f32_16x16x16_bf16 v[224:227], v[80:81], v[72:73], v[224:227]
    v_cvt_pk_bf16_f32 v213, v218, v219
    v_cvt_pk_bf16_f32 v214, v220, v221
    v_mfma_f32_16x16x16_bf16 v[232:235], v[80:81], v[74:75], v[232:235]
    v_cvt_pk_bf16_f32 v215, v222, v223
    v_permlane16_swap_b32 v208, v212
    v_mfma_f32_16x16x16_bf16 v[240:243], v[80:81], v[76:77], v[240:243]
    v_permlane16_swap_b32 v209, v213
    v_mfma_f32_16x16x16_bf16 v[248:251], v[80:81], v[78:79], v[248:251]
    v_permlane16_swap_b32 v210, v214
    s_waitcnt lgkmcnt(1)
    v_mfma_f32_16x16x16_bf16 v[228:231], v[82:83], v[72:73], v[228:231]
    v_permlane16_swap_b32 v211, v215
    v_mfma_f32_16x16x16_bf16 v[236:239], v[82:83], v[74:75], v[236:239]
    v_permlane32_swap_b32 v208, v212
    v_mfma_f32_16x16x16_bf16 v[244:247], v[82:83], v[76:77], v[244:247]
    v_permlane32_swap_b32 v209, v213
    v_mfma_f32_16x16x16_bf16 v[252:255], v[82:83], v[78:79], v[252:255]
    v_permlane32_swap_b32 v210, v214
    v_permlane32_swap_b32 v211, v215
    ds_write_b128 v9, v[212:215] offset:2048
    s_waitcnt vmcnt(0)
    s_mov_b64 exec, 1
    buffer_store_dword v3, v2, s[28:31], s49 offen offset:16 sc1
    s_mov_b64 exec, -1
    buffer_store_dwordx4 v[196:199], v4, s[28:31], s44 offen offset:0 sc1
    buffer_store_dwordx4 v[212:215], v4, s[28:31], s44 offen offset:1024 sc1
    ds_read_b32 v16, v12 offset:0
    ds_read_b32 v17, v12 offset:64
    ds_read_b32 v18, v12 offset:128
    ds_read_b32 v19, v12 offset:192
    v_mov_b32 v7, 159744
    s_waitcnt lgkmcnt(0)
    s_mov_b64 exec, 1
    ds_add_u32 v7, v8 offset:4
    s_mov_b64 exec, -1
    v_mul_f32 v20, 0xbfb8aa3b, v16
    v_mul_f32 v21, v16, v16
    v_rcp_f32 v21, v21
    v_mul_f32 v22, 0xbfb8aa3b, v17
    v_mul_f32 v23, v17, v17
    v_rcp_f32 v23, v23
    v_mul_f32 v24, 0xbfb8aa3b, v18
    v_mul_f32 v25, v18, v18
    v_rcp_f32 v25, v25
    v_mul_f32 v26, 0xbfb8aa3b, v19
    v_mul_f32 v27, v19, v19
    v_rcp_f32 v27, v27
    v_pk_mul_f32 v[28:29], v[20:21], v[128:129] op_sel_hi:[0,1]
    v_pk_mul_f32 v[30:31], v[20:21], v[130:131] op_sel_hi:[0,1]
    v_pk_mul_f32 v[32:33], v[20:21], v[132:133] op_sel_hi:[0,1]
    v_pk_mul_f32 v[34:35], v[20:21], v[134:135] op_sel_hi:[0,1]
    v_exp_f32 v28, v28
    v_exp_f32 v29, v29
    v_pk_mul_f32 v[128:129], v[128:129], v[224:225]
    v_exp_f32 v30, v30
    v_exp_f32 v31, v31
    v_pk_mul_f32 v[130:131], v[130:131], v[226:227]
    v_exp_f32 v32, v32
    v_exp_f32 v33, v33
    v_pk_mul_f32 v[132:133], v[132:133], v[228:229]
    v_exp_f32 v34, v34
    v_exp_f32 v35, v35
    v_pk_mul_f32 v[134:135], v[134:135], v[230:231]
    v_pk_fma_f32 v[28:29], v[28:29], v[20:21], v[20:21] op_sel:[0,1,1]
    v_pk_fma_f32 v[30:31], v[30:31], v[20:21], v[20:21] op_sel:[0,1,1]
    v_pk_fma_f32 v[32:33], v[32:33], v[20:21], v[20:21] op_sel:[0,1,1]
    v_pk_fma_f32 v[34:35], v[34:35], v[20:21], v[20:21] op_sel:[0,1,1]
    v_rcp_f32 v28, v28
    v_rcp_f32 v29, v29
    v_rcp_f32 v30, v30
    v_rcp_f32 v31, v31
    v_rcp_f32 v32, v32
    v_rcp_f32 v33, v33
    v_rcp_f32 v34, v34
    v_rcp_f32 v35, v35
    v_pk_mul_f32 v[128:129], v[128:129], v[28:29]
    v_pk_mul_f32 v[130:131], v[130:131], v[30:31]
    v_pk_mul_f32 v[132:133], v[132:133], v[32:33]
    v_pk_mul_f32 v[134:135], v[134:135], v[34:35]
    v_cvt_pk_bf16_f32 v224, v128, v129
    v_cvt_pk_bf16_f32 v225, v130, v131
    v_cvt_pk_bf16_f32 v226, v132, v133
    v_cvt_pk_bf16_f32 v227, v134, v135
    ds_write_b128 v5, v[224:227] offset:0
    v_pk_mul_f32 v[28:29], v[22:23], v[136:137] op_sel_hi:[0,1]
    v_pk_mul_f32 v[30:31], v[22:23], v[138:139] op_sel_hi:[0,1]
    v_pk_mul_f32 v[32:33], v[22:23], v[140:141] op_sel_hi:[0,1]
    v_pk_mul_f32 v[34:35], v[22:23], v[142:143] op_sel_hi:[0,1]
    v_exp_f32 v28, v28
    v_exp_f32 v29, v29
    v_pk_mul_f32 v[136:137], v[136:137], v[232:233]
    v_exp_f32 v30, v30
    v_exp_f32 v31, v31
    v_pk_mul_f32 v[138:139], v[138:139], v[234:235]
    v_exp_f32 v32, v32
    v_exp_f32 v33, v33
    v_pk_mul_f32 v[140:141], v[140:141], v[236:237]
    v_exp_f32 v34, v34
    v_exp_f32 v35, v35
    v_pk_mul_f32 v[142:143], v[142:143], v[238:239]
    v_pk_fma_f32 v[28:29], v[28:29], v[22:23], v[22:23] op_sel:[0,1,1]
    v_pk_fma_f32 v[30:31], v[30:31], v[22:23], v[22:23] op_sel:[0,1,1]
    v_pk_fma_f32 v[32:33], v[32:33], v[22:23], v[22:23] op_sel:[0,1,1]
    v_pk_fma_f32 v[34:35], v[34:35], v[22:23], v[22:23] op_sel:[0,1,1]
    v_rcp_f32 v28, v28
    v_rcp_f32 v29, v29
    v_rcp_f32 v30, v30
    v_rcp_f32 v31, v31
    v_rcp_f32 v32, v32
    v_rcp_f32 v33, v33
    v_rcp_f32 v34, v34
    v_rcp_f32 v35, v35
    v_pk_mul_f32 v[136:137], v[136:137], v[28:29]
    v_pk_mul_f32 v[138:139], v[138:139], v[30:31]
    v_pk_mul_f32 v[140:141], v[140:141], v[32:33]
    v_pk_mul_f32 v[142:143], v[142:143], v[34:35]
    v_cvt_pk_bf16_f32 v232, v136, v137
    v_cvt_pk_bf16_f32 v233, v138, v139
    v_cvt_pk_bf16_f32 v234, v140, v141
    v_cvt_pk_bf16_f32 v235, v142, v143
    ds_write_b128 v5, v[232:235] offset:256
    v_pk_mul_f32 v[28:29], v[24:25], v[144:145] op_sel_hi:[0,1]
    v_pk_mul_f32 v[30:31], v[24:25], v[146:147] op_sel_hi:[0,1]
    v_pk_mul_f32 v[32:33], v[24:25], v[148:149] op_sel_hi:[0,1]
    v_pk_mul_f32 v[34:35], v[24:25], v[150:151] op_sel_hi:[0,1]
    v_exp_f32 v28, v28
    v_exp_f32 v29, v29
    v_pk_mul_f32 v[144:145], v[144:145], v[240:241]
    v_exp_f32 v30, v30
    v_exp_f32 v31, v31
    v_pk_mul_f32 v[146:147], v[146:147], v[242:243]
    v_exp_f32 v32, v32
    v_exp_f32 v33, v33
    v_pk_mul_f32 v[148:149], v[148:149], v[244:245]
    v_exp_f32 v34, v34
    v_exp_f32 v35, v35
    v_pk_mul_f32 v[150:151], v[150:151], v[246:247]
    v_pk_fma_f32 v[28:29], v[28:29], v[24:25], v[24:25] op_sel:[0,1,1]
    v_pk_fma_f32 v[30:31], v[30:31], v[24:25], v[24:25] op_sel:[0,1,1]
    v_pk_fma_f32 v[32:33], v[32:33], v[24:25], v[24:25] op_sel:[0,1,1]
    v_pk_fma_f32 v[34:35], v[34:35], v[24:25], v[24:25] op_sel:[0,1,1]
    v_rcp_f32 v28, v28
    v_rcp_f32 v29, v29
    v_rcp_f32 v30, v30
    v_rcp_f32 v31, v31
    v_rcp_f32 v32, v32
    v_rcp_f32 v33, v33
    v_rcp_f32 v34, v34
    v_rcp_f32 v35, v35
    v_pk_mul_f32 v[144:145], v[144:145], v[28:29]
    v_pk_mul_f32 v[146:147], v[146:147], v[30:31]
    v_pk_mul_f32 v[148:149], v[148:149], v[32:33]
    v_pk_mul_f32 v[150:151], v[150:151], v[34:35]
    v_cvt_pk_bf16_f32 v240, v144, v145
    v_cvt_pk_bf16_f32 v241, v146, v147
    v_cvt_pk_bf16_f32 v242, v148, v149
    v_cvt_pk_bf16_f32 v243, v150, v151
    ds_write_b128 v5, v[240:243] offset:8192
    v_pk_mul_f32 v[28:29], v[26:27], v[152:153] op_sel_hi:[0,1]
    v_pk_mul_f32 v[30:31], v[26:27], v[154:155] op_sel_hi:[0,1]
    v_pk_mul_f32 v[32:33], v[26:27], v[156:157] op_sel_hi:[0,1]
    v_pk_mul_f32 v[34:35], v[26:27], v[158:159] op_sel_hi:[0,1]
    v_exp_f32 v28, v28
    v_exp_f32 v29, v29
    v_pk_mul_f32 v[152:153], v[152:153], v[248:249]
    v_exp_f32 v30, v30
    v_exp_f32 v31, v31
    v_pk_mul_f32 v[154:155], v[154:155], v[250:251]
    v_exp_f32 v32, v32
    v_exp_f32 v33, v33
    v_pk_mul_f32 v[156:157], v[156:157], v[252:253]
    v_exp_f32 v34, v34
    v_exp_f32 v35, v35
    v_pk_mul_f32 v[158:159], v[158:159], v[254:255]
    v_pk_fma_f32 v[28:29], v[28:29], v[26:27], v[26:27] op_sel:[0,1,1]
    v_pk_fma_f32 v[30:31], v[30:31], v[26:27], v[26:27] op_sel:[0,1,1]
    v_pk_fma_f32 v[32:33], v[32:33], v[26:27], v[26:27] op_sel:[0,1,1]
    v_pk_fma_f32 v[34:35], v[34:35], v[26:27], v[26:27] op_sel:[0,1,1]
    v_rcp_f32 v28, v28
    v_rcp_f32 v29, v29
    v_rcp_f32 v30, v30
    v_rcp_f32 v31, v31
    v_rcp_f32 v32, v32
    v_rcp_f32 v33, v33
    v_rcp_f32 v34, v34
    v_rcp_f32 v35, v35
    v_pk_mul_f32 v[152:153], v[152:153], v[28:29]
    v_pk_mul_f32 v[154:155], v[154:155], v[30:31]
    v_pk_mul_f32 v[156:157], v[156:157], v[32:33]
    v_pk_mul_f32 v[158:159], v[158:159], v[34:35]
    v_cvt_pk_bf16_f32 v248, v152, v153
    v_cvt_pk_bf16_f32 v249, v154, v155
    v_cvt_pk_bf16_f32 v250, v156, v157
    v_cvt_pk_bf16_f32 v251, v158, v159
    ds_write_b128 v5, v[248:251] offset:8448
    s_waitcnt vmcnt(0)
    s_mov_b64 exec, 1
    buffer_store_dword v3, v2, s[28:31], s49 offen sc1
    s_mov_b64 exec, -1
    s_branch L_att
L_loop_in:
    ds_read_b64_tr_b16 v[48:49], v14 offset:0
    ds_read_b64_tr_b16 v[50:51], v14 offset:256
    ds_read_b64_tr_b16 v[52:53], v14 offset:2048
    ds_read_b64_tr_b16 v[54:55], v14 offset:2304
    ds_read_b64_tr_b16 v[56:57], v15 offset:0
    ds_read_b128 v[16:19], v12 offset:0
    ds_read_b128 v[20:23], v13 offset:0
    ds_read_b64_tr_b16 v[58:59], v15 offset:256
    ds_read_b64_tr_b16 v[60:61], v15 offset:2048
    ds_read_b64_tr_b16 v[62:63], v15 offset:2304
    ds_read_b128 v[24:27], v12 offset:2048
    ds_read_b128 v[28:31], v13 offset:2048
    ds_read_b128 v[32:35], v12 offset:4096
    ds_read_b128 v[36:39], v13 offset:4096
    ds_read_b128 v[40:43], v12 offset:6144
    ds_read_b128 v[44:47], v13 offset:6144
.p2align 6
L_loop:
    s_waitcnt lgkmcnt(6)
    v_mfma_f32_16x16x32_bf16 v[192:195], v[48:51], v[16:19], v[192:195]
    ds_read_b64_tr_b16 v[64:65], v14 offset:12288
    v_mfma_f32_16x16x32_bf16 v[192:195], v[52:55], v[20:23], v[192:195]
    ds_read_b64_tr_b16 v[66:67], v14 offset:12544
    v_mfma_f32_16x16x32_bf16 v[196:199], v[56:59], v[16:19], v[196:199]
    ds_read_b64_tr_b16 v[68:69], v14 offset:14336
    v_mfma_f32_16x16x32_bf16 v[196:199], v[60:63], v[20:23], v[196:199]
    ds_read_b64_tr_b16 v[70:71], v14 offset:14592
    s_waitcnt lgkmcnt(8)
    v_mfma_f32_16x16x32_bf16 v[200:203], v[48:51], v[24:27], v[200:203]
    ds_read_b64_tr_b16 v[72:73], v15 offset:12288
    v_mfma_f32_16x16x32_bf16 v[200:203], v[52:55], v[28:31], v[200:203]
    ds_read_b64_tr_b16 v[74:75], v15 offset:12544
    v_mfma_f32_16x16x32_bf16 v[204:207], v[56:59], v[24:27], v[204:207]
    ds_read_b64_tr_b16 v[76:77], v15 offset:14336
    v_mfma_f32_16x16x32_bf16 v[204:207], v[60:63], v[28:31], v[204:207]
    ds_read_b64_tr_b16 v[78:79], v15 offset:14592
    s_waitcnt lgkmcnt(10)
    v_mfma_f32_16x16x32_bf16 v[208:211], v[48:51], v[32:35], v[208:211]
    v_mfma_f32_16x16x32_bf16 v[208:211], v[52:55], v[36:39], v[208:211]
    v_mfma_f32_16x16x32_bf16 v[212:215], v[56:59], v[32:35], v[212:215]
    v_mfma_f32_16x16x32_bf16 v[212:215], v[60:63], v[36:39], v[212:215]
    s_waitcnt lgkmcnt(8)
    v_mfma_f32_16x16x32_bf16 v[216:219], v[48:51], v[40:43], v[216:219]
    v_mfma_f32_16x16x32_bf16 v[216:219], v[52:55], v[44:47], v[216:219]
    v_mfma_f32_16x16x32_bf16 v[220:223], v[56:59], v[40:43], v[220:223]
    v_mfma_f32_16x16x32_bf16 v[220:223], v[60:63], v[44:47], v[220:223]
    s_waitcnt lgkmcnt(0)
    v_mfma_f32_16x16x32_bf16 v[160:163], v[64:67], v[16:19], v[160:163]
    ds_read_b64_tr_b16 v[80:81], v14 offset:16384
    v_mfma_f32_16x16x32_bf16 v[160:163], v[68:71], v[20:23], v[160:163]
    ds_read_b64_tr_b16 v[82:83], v14 offset:16640
    v_mfma_f32_16x16x32_bf16 v[164:167], v[72:75], v[16:19], v[164:167]
    ds_read_b64_tr_b16 v[84:85], v14 offset:18432
    v_mfma_f32_16x16x32_bf16 v[164:167], v[76:79], v[20:23], v[164:167]
    ds_read_b64_tr_b16 v[86:87], v14 offset:18688
    v_mfma_f32_16x16x32_bf16 v[168:171], v[64:67], v[24:27], v[168:171]
    ds_read_b64_tr_b16 v[48:49], v15 offset:16384
    v_mfma_f32_16x16x32_bf16 v[168:171], v[68:71], v[28:31], v[168:171]
    ds_read_b64_tr_b16 v[50:51], v15 offset:16640
    v_mfma_f32_16x16x32_bf16 v[172:175], v[72:75], v[24:27], v[172:175]
    ds_read_b64_tr_b16 v[52:53], v15 offset:18432
    v_mfma_f32_16x16x32_bf16 v[172:175], v[76:79], v[28:31], v[172:175]
    ds_read_b64_tr_b16 v[54:55], v15 offset:18688
    v_mfma_f32_16x16x32_bf16 v[176:179], v[64:67], v[32:35], v[176:179]
    v_mfma_f32_16x16x32_bf16 v[176:179], v[68:71], v[36:39], v[176:179]
    v_mfma_f32_16x16x32_bf16 v[180:183], v[72:75], v[32:35], v[180:183]
    v_mfma_f32_16x16x32_bf16 v[180:183], v[76:79], v[36:39], v[180:183]
    v_mfma_f32_16x16x32_bf16 v[184:187], v[64:67], v[40:43], v[184:187]
    v_mfma_f32_16x16x32_bf16 v[184:187], v[68:71], v[44:47], v[184:187]
    v_mfma_f32_16x16x32_bf16 v[188:191], v[72:75], v[40:43], v[188:191]
    v_mfma_f32_16x16x32_bf16 v[188:191], v[76:79], v[44:47], v[188:191]
    s_waitcnt lgkmcnt(0)
    v_mfma_f32_16x16x32_bf16 v[224:227], v[80:83], v[16:19], v[224:227]
    ds_read_b64_tr_b16 v[56:57], v14 offset:4096
    v_mfma_f32_16x16x32_bf16 v[224:227], v[84:87], v[20:23], v[224:227]
    ds_read_b64_tr_b16 v[58:59], v14 offset:4352
    v_mfma_f32_16x16x32_bf16 v[228:231], v[48:51], v[16:19], v[228:231]
    ds_read_b64_tr_b16 v[60:61], v14 offset:6144
    v_mfma_f32_16x16x32_bf16 v[228:231], v[52:55], v[20:23], v[228:231]
    ds_read_b64_tr_b16 v[62:63], v14 offset:6400
    v_mfma_f32_16x16x32_bf16 v[232:235], v[80:83], v[24:27], v[232:235]
    ds_read_b64_tr_b16 v[64:65], v15 offset:4096
    v_mfma_f32_16x16x32_bf16 v[232:235], v[84:87], v[28:31], v[232:235]
    ds_read_b64_tr_b16 v[66:67], v15 offset:4352
    v_mfma_f32_16x16x32_bf16 v[236:239], v[48:51], v[24:27], v[236:239]
    ds_read_b64_tr_b16 v[68:69], v15 offset:6144
    v_mfma_f32_16x16x32_bf16 v[236:239], v[52:55], v[28:31], v[236:239]
    ds_read_b64_tr_b16 v[70:71], v15 offset:6400
    v_mfma_f32_16x16x32_bf16 v[240:243], v[80:83], v[32:35], v[240:243]
    v_mfma_f32_16x16x32_bf16 v[240:243], v[84:87], v[36:39], v[240:243]
    v_mfma_f32_16x16x32_bf16 v[244:247], v[48:51], v[32:35], v[244:247]
    v_mfma_f32_16x16x32_bf16 v[244:247], v[52:55], v[36:39], v[244:247]
    v_mfma_f32_16x16x32_bf16 v[248:251], v[80:83], v[40:43], v[248:251]
    v_mfma_f32_16x16x32_bf16 v[248:251], v[84:87], v[44:47], v[248:251]
    v_mfma_f32_16x16x32_bf16 v[252:255], v[48:51], v[40:43], v[252:255]
    v_mfma_f32_16x16x32_bf16 v[252:255], v[52:55], v[44:47], v[252:255]
    s_waitcnt lgkmcnt(0)
    v_mfma_f32_16x16x32_bf16 v[96:99], v[56:59], v[16:19], v[96:99]
    ds_read_b64_tr_b16 v[72:73], v14 offset:8192
    v_mfma_f32_16x16x32_bf16 v[96:99], v[60:63], v[20:23], v[96:99]
    ds_read_b64_tr_b16 v[74:75], v14 offset:8448
    v_mfma_f32_16x16x32_bf16 v[100:103], v[64:67], v[16:19], v[100:103]
    ds_read_b64_tr_b16 v[76:77], v14 offset:10240
    v_mfma_f32_16x16x32_bf16 v[100:103], v[68:71], v[20:23], v[100:103]
    ds_read_b64_tr_b16 v[78:79], v14 offset:10496
    v_mfma_f32_16x16x32_bf16 v[104:107], v[56:59], v[24:27], v[104:107]
    ds_read_b64_tr_b16 v[80:81], v15 offset:8192
    v_mfma_f32_16x16x32_bf16 v[104:107], v[60:63], v[28:31], v[104:107]
    ds_read_b64_tr_b16 v[82:83], v15 offset:8448
    v_mfma_f32_16x16x32_bf16 v[108:111], v[64:67], v[24:27], v[108:111]
    ds_read_b64_tr_b16 v[84:85], v15 offset:10240
    v_mfma_f32_16x16x32_bf16 v[108:111], v[68:71], v[28:31], v[108:111]
    ds_read_b64_tr_b16 v[86:87], v15 offset:10496
    v_mfma_f32_16x16x32_bf16 v[112:115], v[56:59], v[32:35], v[112:115]
    s_add_u32 s45, s45, 53248
    v_mfma_f32_16x16x32_bf16 v[112:115], v[60:63], v[36:39], v[112:115]
    s_cmp_eq_u32 s45, 159744
    v_mfma_f32_16x16x32_bf16 v[116:119], v[64:67], v[32:35], v[116:119]
    s_cselect_b32 s45, 0, s45
    v_mfma_f32_16x16x32_bf16 v[116:119], v[68:71], v[36:39], v[116:119]
    v_add_u32 v12, s45, v10
    v_mfma_f32_16x16x32_bf16 v[120:123], v[56:59], v[40:43], v[120:123]
    v_add_u32 v14, s45, v11
    v_mfma_f32_16x16x32_bf16 v[120:123], v[60:63], v[44:47], v[120:123]
    v_xor_b32 v13, 64, v12
    v_mfma_f32_16x16x32_bf16 v[124:127], v[64:67], v[40:43], v[124:127]
    v_xor_b32 v15, 16, v14
    v_mfma_f32_16x16x32_bf16 v[124:127], v[68:71], v[44:47], v[124:127]
    s_waitcnt lgkmcnt(0)
    v_mfma_f32_16x16x32_bf16 v[128:131], v[72:75], v[16:19], v[128:131]
    s_barrier
    ds_read_b64_tr_b16 v[48:49], v14 offset:0
    v_mfma_f32_16x16x32_bf16 v[128:131], v[76:79], v[20:23], v[128:131]
    ds_read_b64_tr_b16 v[50:51], v14 offset:256
    ds_read_b64_tr_b16 v[52:53], v14 offset:2048
    v_mfma_f32_16x16x32_bf16 v[132:135], v[80:83], v[16:19], v[132:135]
    ds_read_b64_tr_b16 v[54:55], v14 offset:2304
    ds_read_b64_tr_b16 v[56:57], v15 offset:0
    v_mfma_f32_16x16x32_bf16 v[132:135], v[84:87], v[20:23], v[132:135]
    ds_read_b128 v[16:19], v12 offset:0
    v_mfma_f32_16x16x32_bf16 v[136:139], v[72:75], v[24:27], v[136:139]
    ds_read_b128 v[20:23], v13 offset:0
    v_mfma_f32_16x16x32_bf16 v[136:139], v[76:79], v[28:31], v[136:139]
    ds_read_b64_tr_b16 v[58:59], v15 offset:256
    ds_read_b64_tr_b16 v[60:61], v15 offset:2048
    v_mfma_f32_16x16x32_bf16 v[140:143], v[80:83], v[24:27], v[140:143]
    ds_read_b64_tr_b16 v[62:63], v15 offset:2304
    v_mfma_f32_16x16x32_bf16 v[140:143], v[84:87], v[28:31], v[140:143]
    ds_read_b128 v[24:27], v12 offset:2048
    v_mfma_f32_16x16x32_bf16 v[144:147], v[72:75], v[32:35], v[144:147]
    ds_read_b128 v[28:31], v13 offset:2048
    v_mfma_f32_16x16x32_bf16 v[144:147], v[76:79], v[36:39], v[144:147]
    v_mfma_f32_16x16x32_bf16 v[148:151], v[80:83], v[32:35], v[148:151]
    v_mfma_f32_16x16x32_bf16 v[148:151], v[84:87], v[36:39], v[148:151]
    ds_read_b128 v[32:35], v12 offset:4096
    v_mfma_f32_16x16x32_bf16 v[152:155], v[72:75], v[40:43], v[152:155]
    s_sub_u32 s46, s46, 1
    ds_read_b128 v[36:39], v13 offset:4096
    v_mfma_f32_16x16x32_bf16 v[152:155], v[76:79], v[44:47], v[152:155]
    v_mfma_f32_16x16x32_bf16 v[156:159], v[80:83], v[40:43], v[156:159]
    v_mfma_f32_16x16x32_bf16 v[156:159], v[84:87], v[44:47], v[156:159]
    ds_read_b128 v[40:43], v12 offset:6144
    ds_read_b128 v[44:47], v13 offset:6144
    s_cbranch_scc0 L_loop
    s_waitcnt lgkmcnt(6)
    v_mfma_f32_16x16x32_bf16 v[192:195], v[48:51], v[16:19], v[192:195]
    v_and_b32 v7, 15, v1
    v_lshrrev_b32 v6, 4, v1
    v_mfma_f32_16x16x32_bf16 v[192:195], v[52:55], v[20:23], v[192:195]
    s_lshl_b32 s47, s36, 10
    s_add_u32 s47, s47, 111616
    s_waitcnt lgkmcnt(4)
    v_mfma_f32_16x16x32_bf16 v[200:203], v[48:51], v[24:27], v[200:203]
    v_lshl_add_u32 v11, v7, 4, s47
    v_lshlrev_b32 v10, 5, v7
    v_mfma_f32_16x16x32_bf16 v[200:203], v[52:55], v[28:31], v[200:203]
    v_lshl_add_u32 v10, v6, 3, v10
    v_add_u32 v10, 106496, v10
    s_waitcnt lgkmcnt(2)
    v_mfma_f32_16x16x32_bf16 v[208:211], v[48:51], v[32:35], v[208:211]
    ds_read_b64 v[72:73], v11 offset:0
    s_lshl_b32 s47, s36, 8
    v_mfma_f32_16x16x32_bf16 v[208:211], v[52:55], v[36:39], v[208:211]
    ds_read_b64 v[74:75], v11 offset:256
    s_add_u32 s47, s47, 115712
    s_waitcnt lgkmcnt(2)
    v_mfma_f32_16x16x32_bf16 v[216:219], v[48:51], v[40:43], v[216:219]
    ds_read_b64 v[76:77], v11 offset:512
    v_lshl_add_u32 v12, v7, 2, s47
    v_mfma_f32_16x16x32_bf16 v[216:219], v[52:55], v[44:47], v[216:219]
    ds_read_b64 v[78:79], v11 offset:768
    v_lshl_add_u32 v13, v6, 4, s47
    v_mfma_f32_16x16x32_bf16 v[196:199], v[56:59], v[16:19], v[196:199]
    ds_read_b64 v[80:81], v10 offset:0
    s_lshl_b32 s41, s37, 2
    v_mfma_f32_16x16x32_bf16 v[196:199], v[60:63], v[20:23], v[196:199]
    ds_read_b64 v[82:83], v10 offset:512
    s_add_u32 s41, s41, s36
    v_mfma_f32_16x16x32_bf16 v[204:207], v[56:59], v[24:27], v[204:207]
    ds_read_b64_tr_b16 v[64:65], v14 offset:12288
    s_lshl_b32 s39, s41, 16
    v_mfma_f32_16x16x32_bf16 v[204:207], v[60:63], v[28:31], v[204:207]
    ds_read_b64_tr_b16 v[66:67], v14 offset:12544
    s_lshl_b32 s48, s38, 10
    v_mfma_f32_16x16x32_bf16 v[212:215], v[56:59], v[32:35], v[212:215]
    ds_read_b64_tr_b16 v[68:69], v14 offset:14336
    s_add_u32 s39, s39, s48
    v_mfma_f32_16x16x32_bf16 v[212:215], v[60:63], v[36:39], v[212:215]
    ds_read_b64_tr_b16 v[70:71], v14 offset:14592
    s_add_u32 s39, s39, 6291456
    v_mfma_f32_16x16x32_bf16 v[220:223], v[56:59], v[40:43], v[220:223]
    s_add_u32 s40, s39, 0x8000
    s_lshl_b32 s41, s41, 11
    v_mfma_f32_16x16x32_bf16 v[220:223], v[60:63], v[44:47], v[220:223]
    s_lshl_b32 s44, s38, 16
    s_add_u32 s44, s44, s41
    s_waitcnt lgkmcnt(6)
    s_waitcnt lgkmcnt(5)
    v_mfma_f32_16x16x16_bf16 v[192:195], v[80:81], v[72:73], v[192:195]
    ds_read_b64_tr_b16 v[48:49], v15 offset:12288
    s_add_u32 s44, s44, 2097152
    v_mfma_f32_16x16x16_bf16 v[200:203], v[80:81], v[74:75], v[200:203]
    ds_read_b64_tr_b16 v[50:51], v15 offset:12544
    s_lshl_b32 s48, s36, 12
    v_mfma_f32_16x16x16_bf16 v[208:211], v[80:81], v[76:77], v[208:211]
    ds_read_b64_tr_b16 v[52:53], v15 offset:14336
    s_add_u32 s48, s48, 32768
    v_mfma_f32_16x16x16_bf16 v[216:219], v[80:81], v[78:79], v[216:219]
    ds_read_b64_tr_b16 v[54:55], v15 offset:14592
    v_add_u32 v9, s48, v4
    s_waitcnt lgkmcnt(8)
    v_mfma_f32_16x16x16_bf16 v[196:199], v[82:83], v[72:73], v[196:199]
    s_lshl_b32 s48, s36, 11
    s_add_u32 s48, s48, 0
    v_mfma_f32_16x16x16_bf16 v[204:207], v[82:83], v[74:75], v[204:207]
    v_lshl_add_u32 v5, v7, 4, s48
    v_lshl_add_u32 v5, v6, 9, v5
    v_mfma_f32_16x16x16_bf16 v[212:215], v[82:83], v[76:77], v[212:215]
    ds_read_b32 v84, v12 offset:0
    ds_read_b32 v85, v12 offset:64
    v_mfma_f32_16x16x16_bf16 v[220:223], v[82:83], v[78:79], v[220:223]
    ds_read_b32 v86, v12 offset:128
    ds_read_b32 v87, v12 offset:192
    s_waitcnt lgkmcnt(8)
    v_mfma_f32_16x16x32_bf16 v[160:163], v[64:67], v[16:19], v[160:163]
    v_mfma_f32_16x16x32_bf16 v[160:163], v[68:71], v[20:23], v[160:163]
    v_mfma_f32_16x16x32_bf16 v[168:171], v[64:67], v[24:27], v[168:171]
    ds_read_b64 v[80:81], v10 offset:3072
    v_mfma_f32_16x16x32_bf16 v[168:171], v[68:71], v[28:31], v[168:171]
    ds_read_b64 v[82:83], v10 offset:3584
    s_waitcnt lgkmcnt(2)
    v_mfma_f32_16x16x32_bf16 v[176:179], v[64:67], v[32:35], v[176:179]
    s_mov_b32 exec_hi, 0
    v_mul_f32 v84, 0x3eb8aa3b, v84
    v_mul_f32 v85, 0x3eb8aa3b, v85
    v_mul_f32 v86, 0x3eb8aa3b, v86
    v_mul_f32 v87, 0x3eb8aa3b, v87
    s_mov_b32 exec_hi, -1
    v_mfma_f32_16x16x32_bf16 v[176:179], v[68:71], v[36:39], v[176:179]
    v_mul_f32 v192, v84, v192
    v_mul_f32 v193, v84, v193
    v_mfma_f32_16x16x32_bf16 v[184:187], v[64:67], v[40:43], v[184:187]
    v_mul_f32 v194, v84, v194
    v_mul_f32 v195, v84, v195
    v_mfma_f32_16x16x32_bf16 v[184:187], v[68:71], v[44:47], v[184:187]
    v_mul_f32 v196, v84, v196
    v_mul_f32 v197, v84, v197
    v_mfma_f32_16x16x32_bf16 v[164:167], v[48:51], v[16:19], v[164:167]
    v_mul_f32 v198, v84, v198
    v_mul_f32 v199, v84, v199
    v_mfma_f32_16x16x32_bf16 v[164:167], v[52:55], v[20:23], v[164:167]
    v_mul_f32 v200, v85, v200
    v_mul_f32 v201, v85, v201
    v_mfma_f32_16x16x32_bf16 v[172:175], v[48:51], v[24:27], v[172:175]
    ds_read_b64_tr_b16 v[56:57], v14 offset:16384
    v_mul_f32 v202, v85, v202
    v_mfma_f32_16x16x32_bf16 v[172:175], v[52:55], v[28:31], v[172:175]
    ds_read_b64_tr_b16 v[58:59], v14 offset:16640
    v_mul_f32 v203, v85, v203
    v_mfma_f32_16x16x32_bf16 v[180:183], v[48:51], v[32:35], v[180:183]
    ds_read_b64_tr_b16 v[60:61], v14 offset:18432
    v_mul_f32 v204, v85, v204
    v_mfma_f32_16x16x32_bf16 v[180:183], v[52:55], v[36:39], v[180:183]
    ds_read_b64_tr_b16 v[62:63], v14 offset:18688
    v_mul_f32 v205, v85, v205
    v_mfma_f32_16x16x32_bf16 v[188:191], v[48:51], v[40:43], v[188:191]
    v_mul_f32 v206, v85, v206
    v_mul_f32 v207, v85, v207
    v_mfma_f32_16x16x32_bf16 v[188:191], v[52:55], v[44:47], v[188:191]
    v_cvt_pk_bf16_f32 v192, v192, v193
    v_cvt_pk_bf16_f32 v193, v194, v195
    s_waitcnt lgkmcnt(5)
    v_mfma_f32_16x16x16_bf16 v[160:163], v[80:81], v[72:73], v[160:163]
    ds_read_b64_tr_b16 v[64:65], v15 offset:16384
    v_cvt_pk_bf16_f32 v194, v196, v197
    v_mfma_f32_16x16x16_bf16 v[168:171], v[80:81], v[74:75], v[168:171]
    ds_read_b64_tr_b16 v[66:67], v15 offset:16640
    v_cvt_pk_bf16_f32 v195, v198, v199
    v_mfma_f32_16x16x16_bf16 v[176:179], v[80:81], v[76:77], v[176:179]
    ds_read_b64_tr_b16 v[68:69], v15 offset:18432
    v_cvt_pk_bf16_f32 v196, v200, v201
    v_mfma_f32_16x16x16_bf16 v[184:187], v[80:81], v[78:79], v[184:187]
    ds_read_b64_tr_b16 v[70:71], v15 offset:18688
    v_cvt_pk_bf16_f32 v197, v202, v203
    s_waitcnt lgkmcnt(8)
    v_mfma_f32_16x16x16_bf16 v[164:167], v[82:83], v[72:73], v[164:167]
    v_cvt_pk_bf16_f32 v198, v204, v205
    v_cvt_pk_bf16_f32 v199, v206, v207
    v_mfma_f32_16x16x16_bf16 v[172:175], v[82:83], v[74:75], v[172:175]
    v_permlane16_swap_b32 v192, v196
    v_mfma_f32_16x16x16_bf16 v[180:183], v[82:83], v[76:77], v[180:183]
    v_permlane16_swap_b32 v193, v197
    v_mfma_f32_16x16x16_bf16 v[188:191], v[82:83], v[78:79], v[188:191]
    v_permlane16_swap_b32 v194, v198
    s_waitcnt lgkmcnt(4)
    v_mfma_f32_16x16x32_bf16 v[224:227], v[56:59], v[16:19], v[224:227]
    v_permlane16_swap_b32 v195, v199
    v_mfma_f32_16x16x32_bf16 v[224:227], v[60:63], v[20:23], v[224:227]
    v_permlane32_swap_b32 v192, v196
    v_mfma_f32_16x16x32_bf16 v[232:235], v[56:59], v[24:27], v[232:235]
    ds_read_b64 v[80:81], v10 offset:4096
    v_permlane32_swap_b32 v193, v197
    v_mfma_f32_16x16x32_bf16 v[232:235], v[60:63], v[28:31], v[232:235]
    ds_read_b64 v[82:83], v10 offset:4608
    v_permlane32_swap_b32 v194, v198
    v_mfma_f32_16x16x32_bf16 v[240:243], v[56:59], v[32:35], v[240:243]
    v_permlane32_swap_b32 v195, v199
    v_mfma_f32_16x16x32_bf16 v[240:243], v[60:63], v[36:39], v[240:243]
    buffer_store_dwordx4 v[196:199], v4, s[28:31], s44 offen offset:0 sc1
    v_mfma_f32_16x16x32_bf16 v[248:251], v[56:59], v[40:43], v[248:251]
    ds_write_b128 v9, v[196:199] offset:0
    v_mul_f32 v208, v86, v208
    v_mfma_f32_16x16x32_bf16 v[248:251], v[60:63], v[44:47], v[248:251]
    v_mul_f32 v209, v86, v209
    v_mul_f32 v210, v86, v210
    s_waitcnt lgkmcnt(3)
    v_mfma_f32_16x16x32_bf16 v[228:231], v[64:67], v[16:19], v[228:231]
    v_mul_f32 v211, v86, v211
    v_mul_f32 v212, v86, v212
    v_mfma_f32_16x16x32_bf16 v[228:231], v[68:71], v[20:23], v[228:231]
    v_mul_f32 v213, v86, v213
    v_mul_f32 v214, v86, v214
    v_mfma_f32_16x16x32_bf16 v[236:239], v[64:67], v[24:27], v[236:239]
    ds_read_b64_tr_b16 v[48:49], v14 offset:4096
    v_mul_f32 v215, v86, v215
    v_mfma_f32_16x16x32_bf16 v[236:239], v[68:71], v[28:31], v[236:239]
    ds_read_b64_tr_b16 v[50:51], v14 offset:4352
    v_mul_f32 v216, v87, v216
    v_mfma_f32_16x16x32_bf16 v[244:247], v[64:67], v[32:35], v[244:247]
    ds_read_b64_tr_b16 v[52:53], v14 offset:6144
    v_mul_f32 v217, v87, v217
    v_mfma_f32_16x16x32_bf16 v[244:247], v[68:71], v[36:39], v[244:247]
    ds_read_b64_tr_b16 v[54:55], v14 offset:6400
    v_mul_f32 v218, v87, v218
    v_mfma_f32_16x16x32_bf16 v[252:255], v[64:67], v[40:43], v[252:255]
    v_mul_f32 v219, v87, v219
    v_mul_f32 v220, v87, v220
    v_mfma_f32_16x16x32_bf16 v[252:255], v[68:71], v[44:47], v[252:255]
    v_mul_f32 v221, v87, v221
    v_mul_f32 v222, v87, v222
    s_waitcnt lgkmcnt(6)
    v_mfma_f32_16x16x16_bf16 v[224:227], v[80:81], v[72:73], v[224:227]
    ds_read_b64_tr_b16 v[56:57], v15 offset:4096
    v_mul_f32 v223, v87, v223
    v_mfma_f32_16x16x16_bf16 v[232:235], v[80:81], v[74:75], v[232:235]
    ds_read_b64_tr_b16 v[58:59], v15 offset:4352
    v_cvt_pk_bf16_f32 v208, v208, v209
    v_mfma_f32_16x16x16_bf16 v[240:243], v[80:81], v[76:77], v[240:243]
    ds_read_b64_tr_b16 v[60:61], v15 offset:6144
    v_cvt_pk_bf16_f32 v209, v210, v211
    v_mfma_f32_16x16x16_bf16 v[248:251], v[80:81], v[78:79], v[248:251]
    ds_read_b64_tr_b16 v[62:63], v15 offset:6400
    v_cvt_pk_bf16_f32 v210, v212, v213
    s_waitcnt lgkmcnt(9)
    v_mfma_f32_16x16x16_bf16 v[228:231], v[82:83], v[72:73], v[228:231]
    v_cvt_pk_bf16_f32 v211, v214, v215
    v_cvt_pk_bf16_f32 v212, v216, v217
    v_mfma_f32_16x16x16_bf16 v[236:239], v[82:83], v[74:75], v[236:239]
    v_cvt_pk_bf16_f32 v213, v218, v219
    v_cvt_pk_bf16_f32 v214, v220, v221
    v_mfma_f32_16x16x16_bf16 v[244:247], v[82:83], v[76:77], v[244:247]
    v_cvt_pk_bf16_f32 v215, v222, v223
    v_permlane16_swap_b32 v208, v212
    v_mfma_f32_16x16x16_bf16 v[252:255], v[82:83], v[78:79], v[252:255]
    v_permlane16_swap_b32 v209, v213
    s_waitcnt lgkmcnt(4)
    v_mfma_f32_16x16x32_bf16 v[96:99], v[48:51], v[16:19], v[96:99]
    v_permlane16_swap_b32 v210, v214
    v_mfma_f32_16x16x32_bf16 v[96:99], v[52:55], v[20:23], v[96:99]
    v_permlane16_swap_b32 v211, v215
    v_mfma_f32_16x16x32_bf16 v[104:107], v[48:51], v[24:27], v[104:107]
    ds_read_b64 v[80:81], v10 offset:1024
    v_permlane32_swap_b32 v208, v212
    v_mfma_f32_16x16x32_bf16 v[104:107], v[52:55], v[28:31], v[104:107]
    ds_read_b64 v[82:83], v10 offset:1536
    v_permlane32_swap_b32 v209, v213
    v_mfma_f32_16x16x32_bf16 v[112:115], v[48:51], v[32:35], v[112:115]
    v_permlane32_swap_b32 v210, v214
    v_mfma_f32_16x16x32_bf16 v[112:115], v[52:55], v[36:39], v[112:115]
    v_permlane32_swap_b32 v211, v215
    v_mfma_f32_16x16x32_bf16 v[120:123], v[48:51], v[40:43], v[120:123]
    buffer_store_dwordx4 v[212:215], v4, s[28:31], s44 offen offset:1024 sc1
    v_mfma_f32_16x16x32_bf16 v[120:123], v[52:55], v[44:47], v[120:123]
    ds_write_b128 v9, v[212:215] offset:2048
    s_waitcnt lgkmcnt(3)
    v_mfma_f32_16x16x32_bf16 v[100:103], v[56:59], v[16:19], v[100:103]
    v_mfma_f32_16x16x32_bf16 v[100:103], v[60:63], v[20:23], v[100:103]
    v_mfma_f32_16x16x32_bf16 v[108:111], v[56:59], v[24:27], v[108:111]
    ds_read_b64_tr_b16 v[64:65], v14 offset:8192
    v_mfma_f32_16x16x32_bf16 v[108:111], v[60:63], v[28:31], v[108:111]
    ds_read_b64_tr_b16 v[66:67], v14 offset:8448
    v_mfma_f32_16x16x32_bf16 v[116:119], v[56:59], v[32:35], v[116:119]
    ds_read_b64_tr_b16 v[68:69], v14 offset:10240
    v_mfma_f32_16x16x32_bf16 v[116:119], v[60:63], v[36:39], v[116:119]
    ds_read_b64_tr_b16 v[70:71], v14 offset:10496
    v_mfma_f32_16x16x32_bf16 v[124:127], v[56:59], v[40:43], v[124:127]
    v_mfma_f32_16x16x32_bf16 v[124:127], v[60:63], v[44:47], v[124:127]
    s_waitcnt lgkmcnt(6)
    v_mfma_f32_16x16x16_bf16 v[96:99], v[80:81], v[72:73], v[96:99]
    ds_read_b64_tr_b16 v[48:49], v15 offset:8192
    v_mfma_f32_16x16x16_bf16 v[104:107], v[80:81], v[74:75], v[104:107]
    ds_read_b64_tr_b16 v[50:51], v15 offset:8448
    v_mfma_f32_16x16x16_bf16 v[112:115], v[80:81], v[76:77], v[112:115]
    ds_read_b64_tr_b16 v[52:53], v15 offset:10240
    v_mfma_f32_16x16x16_bf16 v[120:123], v[80:81], v[78:79], v[120:123]
    ds_read_b64_tr_b16 v[54:55], v15 offset:10496
    s_waitcnt lgkmcnt(9)
    v_mfma_f32_16x16x16_bf16 v[100:103], v[82:83], v[72:73], v[100:103]
    v_mfma_f32_16x16x16_bf16 v[108:111], v[82:83], v[74:75], v[108:111]
    v_mfma_f32_16x16x16_bf16 v[116:119], v[82:83], v[76:77], v[116:119]
    v_mfma_f32_16x16x16_bf16 v[124:127], v[82:83], v[78:79], v[124:127]
    s_waitcnt lgkmcnt(4)
    v_mfma_f32_16x16x32_bf16 v[128:131], v[64:67], v[16:19], v[128:131]
    v_mfma_f32_16x16x32_bf16 v[128:131], v[68:71], v[20:23], v[128:131]
    v_mfma_f32_16x16x32_bf16 v[136:139], v[64:67], v[24:27], v[136:139]
    ds_read_b64 v[80:81], v10 offset:2048
    v_mfma_f32_16x16x32_bf16 v[136:139], v[68:71], v[28:31], v[136:139]
    ds_read_b64 v[82:83], v10 offset:2560
    v_mfma_f32_16x16x32_bf16 v[144:147], v[64:67], v[32:35], v[144:147]
    v_mfma_f32_16x16x32_bf16 v[144:147], v[68:71], v[36:39], v[144:147]
    v_mfma_f32_16x16x32_bf16 v[152:155], v[64:67], v[40:43], v[152:155]
    v_mfma_f32_16x16x32_bf16 v[152:155], v[68:71], v[44:47], v[152:155]
    s_waitcnt lgkmcnt(2)
    v_mfma_f32_16x16x32_bf16 v[132:135], v[48:51], v[16:19], v[132:135]
    v_mfma_f32_16x16x32_bf16 v[132:135], v[52:55], v[20:23], v[132:135]
    v_mfma_f32_16x16x32_bf16 v[140:143], v[48:51], v[24:27], v[140:143]
    v_mfma_f32_16x16x32_bf16 v[140:143], v[52:55], v[28:31], v[140:143]
    v_mfma_f32_16x16x32_bf16 v[148:151], v[48:51], v[32:35], v[148:151]
    v_mfma_f32_16x16x32_bf16 v[148:151], v[52:55], v[36:39], v[148:151]
    v_mfma_f32_16x16x32_bf16 v[156:159], v[48:51], v[40:43], v[156:159]
    v_mfma_f32_16x16x32_bf16 v[156:159], v[52:55], v[44:47], v[156:159]
    s_waitcnt lgkmcnt(1)
    v_mfma_f32_16x16x16_bf16 v[128:131], v[80:81], v[72:73], v[128:131]
    v_mfma_f32_16x16x16_bf16 v[136:139], v[80:81], v[74:75], v[136:139]
    v_mfma_f32_16x16x16_bf16 v[144:147], v[80:81], v[76:77], v[144:147]
    v_mfma_f32_16x16x16_bf16 v[152:155], v[80:81], v[78:79], v[152:155]
    s_waitcnt lgkmcnt(0)
    v_mfma_f32_16x16x16_bf16 v[132:135], v[82:83], v[72:73], v[132:135]
    v_mfma_f32_16x16x16_bf16 v[140:143], v[82:83], v[74:75], v[140:143]
    v_mfma_f32_16x16x16_bf16 v[148:151], v[82:83], v[76:77], v[148:151]
    v_mfma_f32_16x16x16_bf16 v[156:159], v[82:83], v[78:79], v[156:159]
    ds_read_b32 v16, v12 offset:0
    ds_read_b32 v17, v12 offset:64
    ds_read_b32 v18, v12 offset:128
    ds_read_b32 v19, v12 offset:192
    v_mov_b32 v7, 159744
    s_waitcnt lgkmcnt(0)
    s_mov_b64 exec, 1
    ds_add_u32 v7, v8 offset:4
    s_mov_b64 exec, -1
    v_mul_f32 v20, 0xbfb8aa3b, v16
    v_mul_f32 v21, v16, v16
    v_rcp_f32 v21, v21
    v_mul_f32 v22, 0xbfb8aa3b, v17
    v_mul_f32 v23, v17, v17
    v_rcp_f32 v23, v23
    v_mul_f32 v24, 0xbfb8aa3b, v18
    v_mul_f32 v25, v18, v18
    v_rcp_f32 v25, v25
    v_mul_f32 v26, 0xbfb8aa3b, v19
    v_mul_f32 v27, v19, v19
    v_rcp_f32 v27, v27
    v_pk_mul_f32 v[28:29], v[20:21], v[160:161] op_sel_hi:[0,1]
    v_pk_mul_f32 v[30:31], v[20:21], v[162:163] op_sel_hi:[0,1]
    v_pk_mul_f32 v[32:33], v[20:21], v[164:165] op_sel_hi:[0,1]
    v_pk_mul_f32 v[34:35], v[20:21], v[166:167] op_sel_hi:[0,1]
    v_exp_f32 v28, v28
    v_exp_f32 v29, v29
    v_pk_mul_f32 v[160:161], v[160:161], v[224:225]
    v_exp_f32 v30, v30
    v_exp_f32 v31, v31
    v_pk_mul_f32 v[162:163], v[162:163], v[226:227]
    v_exp_f32 v32, v32
    v_exp_f32 v33, v33
    v_pk_mul_f32 v[164:165], v[164:165], v[228:229]
    v_exp_f32 v34, v34
    v_exp_f32 v35, v35
    v_pk_mul_f32 v[166:167], v[166:167], v[230:231]
    v_pk_fma_f32 v[28:29], v[28:29], v[20:21], v[20:21] op_sel:[0,1,1]
    v_pk_fma_f32 v[30:31], v[30:31], v[20:21], v[20:21] op_sel:[0,1,1]
    v_pk_fma_f32 v[32:33], v[32:33], v[20:21], v[20:21] op_sel:[0,1,1]
    v_pk_fma_f32 v[34:35], v[34:35], v[20:21], v[20:21] op_sel:[0,1,1]
    v_rcp_f32 v28, v28
    v_rcp_f32 v29, v29
    v_rcp_f32 v30, v30
    v_rcp_f32 v31, v31
    v_rcp_f32 v32, v32
    v_rcp_f32 v33, v33
    v_rcp_f32 v34, v34
    v_rcp_f32 v35, v35
    v_pk_mul_f32 v[160:161], v[160:161], v[28:29]
    v_pk_mul_f32 v[162:163], v[162:163], v[30:31]
    v_pk_mul_f32 v[164:165], v[164:165], v[32:33]
    v_pk_mul_f32 v[166:167], v[166:167], v[34:35]
    v_cvt_pk_bf16_f32 v224, v160, v161
    v_cvt_pk_bf16_f32 v225, v162, v163
    v_cvt_pk_bf16_f32 v226, v164, v165
    v_cvt_pk_bf16_f32 v227, v166, v167
    ds_write_b128 v5, v[224:227] offset:0
    s_waitcnt vmcnt(0)
    s_mov_b64 exec, 1
    buffer_store_dword v3, v2, s[28:31], s49 offen sc1
    s_mov_b64 exec, -1
    v_pk_mul_f32 v[28:29], v[22:23], v[168:169] op_sel_hi:[0,1]
    v_pk_mul_f32 v[30:31], v[22:23], v[170:171] op_sel_hi:[0,1]
    v_pk_mul_f32 v[32:33], v[22:23], v[172:173] op_sel_hi:[0,1]
    v_pk_mul_f32 v[34:35], v[22:23], v[174:175] op_sel_hi:[0,1]
    v_exp_f32 v28, v28
    v_exp_f32 v29, v29
    v_pk_mul_f32 v[168:169], v[168:169], v[232:233]
    v_exp_f32 v30, v30
    v_exp_f32 v31, v31
    v_pk_mul_f32 v[170:171], v[170:171], v[234:235]
    v_exp_f32 v32, v32
    v_exp_f32 v33, v33
    v_pk_mul_f32 v[172:173], v[172:173], v[236:237]
    v_exp_f32 v34, v34
    v_exp_f32 v35, v35
    v_pk_mul_f32 v[174:175], v[174:175], v[238:239]
    v_pk_fma_f32 v[28:29], v[28:29], v[22:23], v[22:23] op_sel:[0,1,1]
    v_pk_fma_f32 v[30:31], v[30:31], v[22:23], v[22:23] op_sel:[0,1,1]
    v_pk_fma_f32 v[32:33], v[32:33], v[22:23], v[22:23] op_sel:[0,1,1]
    v_pk_fma_f32 v[34:35], v[34:35], v[22:23], v[22:23] op_sel:[0,1,1]
    v_rcp_f32 v28, v28
    v_rcp_f32 v29, v29
    v_rcp_f32 v30, v30
    v_rcp_f32 v31, v31
    v_rcp_f32 v32, v32
    v_rcp_f32 v33, v33
    v_rcp_f32 v34, v34
    v_rcp_f32 v35, v35
    v_pk_mul_f32 v[168:169], v[168:169], v[28:29]
    v_pk_mul_f32 v[170:171], v[170:171], v[30:31]
    v_pk_mul_f32 v[172:173], v[172:173], v[32:33]
    v_pk_mul_f32 v[174:175], v[174:175], v[34:35]
    v_cvt_pk_bf16_f32 v232, v168, v169
    v_cvt_pk_bf16_f32 v233, v170, v171
    v_cvt_pk_bf16_f32 v234, v172, v173
    v_cvt_pk_bf16_f32 v235, v174, v175
    ds_write_b128 v5, v[232:235] offset:256
    v_pk_mul_f32 v[28:29], v[24:25], v[176:177] op_sel_hi:[0,1]
    v_pk_mul_f32 v[30:31], v[24:25], v[178:179] op_sel_hi:[0,1]
    v_pk_mul_f32 v[32:33], v[24:25], v[180:181] op_sel_hi:[0,1]
    v_pk_mul_f32 v[34:35], v[24:25], v[182:183] op_sel_hi:[0,1]
    v_exp_f32 v28, v28
    v_exp_f32 v29, v29
    v_pk_mul_f32 v[176:177], v[176:177], v[240:241]
    v_exp_f32 v30, v30
    v_exp_f32 v31, v31
    v_pk_mul_f32 v[178:179], v[178:179], v[242:243]
    v_exp_f32 v32, v32
    v_exp_f32 v33, v33
    v_pk_mul_f32 v[180:181], v[180:181], v[244:245]
    v_exp_f32 v34, v34
    v_exp_f32 v35, v35
    v_pk_mul_f32 v[182:183], v[182:183], v[246:247]
    v_pk_fma_f32 v[28:29], v[28:29], v[24:25], v[24:25] op_sel:[0,1,1]
    v_pk_fma_f32 v[30:31], v[30:31], v[24:25], v[24:25] op_sel:[0,1,1]
    v_pk_fma_f32 v[32:33], v[32:33], v[24:25], v[24:25] op_sel:[0,1,1]
    v_pk_fma_f32 v[34:35], v[34:35], v[24:25], v[24:25] op_sel:[0,1,1]
    v_rcp_f32 v28, v28
    v_rcp_f32 v29, v29
    v_rcp_f32 v30, v30
    v_rcp_f32 v31, v31
    v_rcp_f32 v32, v32
    v_rcp_f32 v33, v33
    v_rcp_f32 v34, v34
    v_rcp_f32 v35, v35
    v_pk_mul_f32 v[176:177], v[176:177], v[28:29]
    v_pk_mul_f32 v[178:179], v[178:179], v[30:31]
    v_pk_mul_f32 v[180:181], v[180:181], v[32:33]
    v_pk_mul_f32 v[182:183], v[182:183], v[34:35]
    v_cvt_pk_bf16_f32 v240, v176, v177
    v_cvt_pk_bf16_f32 v241, v178, v179
    v_cvt_pk_bf16_f32 v242, v180, v181
    v_cvt_pk_bf16_f32 v243, v182, v183
    ds_write_b128 v5, v[240:243] offset:8192
    v_pk_mul_f32 v[28:29], v[26:27], v[184:185] op_sel_hi:[0,1]
    v_pk_mul_f32 v[30:31], v[26:27], v[186:187] op_sel_hi:[0,1]
    v_pk_mul_f32 v[32:33], v[26:27], v[188:189] op_sel_hi:[0,1]
    v_pk_mul_f32 v[34:35], v[26:27], v[190:191] op_sel_hi:[0,1]
    v_exp_f32 v28, v28
    v_exp_f32 v29, v29
    v_pk_mul_f32 v[184:185], v[184:185], v[248:249]
    v_exp_f32 v30, v30
    v_exp_f32 v31, v31
    v_pk_mul_f32 v[186:187], v[186:187], v[250:251]
    v_exp_f32 v32, v32
    v_exp_f32 v33, v33
    v_pk_mul_f32 v[188:189], v[188:189], v[252:253]
    v_exp_f32 v34, v34
    v_exp_f32 v35, v35
    v_pk_mul_f32 v[190:191], v[190:191], v[254:255]
    v_pk_fma_f32 v[28:29], v[28:29], v[26:27], v[26:27] op_sel:[0,1,1]
    v_pk_fma_f32 v[30:31], v[30:31], v[26:27], v[26:27] op_sel:[0,1,1]
    v_pk_fma_f32 v[32:33], v[32:33], v[26:27], v[26:27] op_sel:[0,1,1]
    v_pk_fma_f32 v[34:35], v[34:35], v[26:27], v[26:27] op_sel:[0,1,1]
    v_rcp_f32 v28, v28
    v_rcp_f32 v29, v29
    v_rcp_f32 v30, v30
    v_rcp_f32 v31, v31
    v_rcp_f32 v32, v32
    v_rcp_f32 v33, v33
    v_rcp_f32 v34, v34
    v_rcp_f32 v35, v35
    v_pk_mul_f32 v[184:185], v[184:185], v[28:29]
    v_pk_mul_f32 v[186:187], v[186:187], v[30:31]
    v_pk_mul_f32 v[188:189], v[188:189], v[32:33]
    v_pk_mul_f32 v[190:191], v[190:191], v[34:35]
    v_cvt_pk_bf16_f32 v248, v184, v185
    v_cvt_pk_bf16_f32 v249, v186, v187
    v_cvt_pk_bf16_f32 v250, v188, v189
    v_cvt_pk_bf16_f32 v251, v190, v191
    ds_write_b128 v5, v[248:251] offset:8448
    v_pk_mul_f32 v[28:29], v[20:21], v[96:97] op_sel_hi:[0,1]
    v_pk_mul_f32 v[30:31], v[20:21], v[98:99] op_sel_hi:[0,1]
    v_pk_mul_f32 v[32:33], v[20:21], v[100:101] op_sel_hi:[0,1]
    v_pk_mul_f32 v[34:35], v[20:21], v[102:103] op_sel_hi:[0,1]
    v_exp_f32 v28, v28
    v_exp_f32 v29, v29
    v_pk_mul_f32 v[96:97], v[96:97], v[128:129]
    v_exp_f32 v30, v30
    v_exp_f32 v31, v31
    v_pk_mul_f32 v[98:99], v[98:99], v[130:131]
    v_exp_f32 v32, v32
    v_exp_f32 v33, v33
    v_pk_mul_f32 v[100:101], v[100:101], v[132:133]
    v_exp_f32 v34, v34
    v_exp_f32 v35, v35
    v_pk_mul_f32 v[102:103], v[102:103], v[134:135]
    v_pk_fma_f32 v[28:29], v[28:29], v[20:21], v[20:21] op_sel:[0,1,1]
    v_pk_fma_f32 v[30:31], v[30:31], v[20:21], v[20:21] op_sel:[0,1,1]
    v_pk_fma_f32 v[32:33], v[32:33], v[20:21], v[20:21] op_sel:[0,1,1]
    v_pk_fma_f32 v[34:35], v[34:35], v[20:21], v[20:21] op_sel:[0,1,1]
    v_rcp_f32 v28, v28
    v_rcp_f32 v29, v29
    v_rcp_f32 v30, v30
    v_rcp_f32 v31, v31
    v_rcp_f32 v32, v32
    v_rcp_f32 v33, v33
    v_rcp_f32 v34, v34
    v_rcp_f32 v35, v35
    v_pk_mul_f32 v[96:97], v[96:97], v[28:29]
    v_pk_mul_f32 v[98:99], v[98:99], v[30:31]
    v_pk_mul_f32 v[100:101], v[100:101], v[32:33]
    v_pk_mul_f32 v[102:103], v[102:103], v[34:35]
    v_cvt_pk_bf16_f32 v128, v96, v97
    v_cvt_pk_bf16_f32 v129, v98, v99
    v_cvt_pk_bf16_f32 v130, v100, v101
    v_cvt_pk_bf16_f32 v131, v102, v103
    ds_write_b128 v5, v[128:131] offset:16384
    v_pk_mul_f32 v[28:29], v[22:23], v[104:105] op_sel_hi:[0,1]
    v_pk_mul_f32 v[30:31], v[22:23], v[106:107] op_sel_hi:[0,1]
    v_pk_mul_f32 v[32:33], v[22:23], v[108:109] op_sel_hi:[0,1]
    v_pk_mul_f32 v[34:35], v[22:23], v[110:111] op_sel_hi:[0,1]
    v_exp_f32 v28, v28
    v_exp_f32 v29, v29
    v_pk_mul_f32 v[104:105], v[104:105], v[136:137]
    v_exp_f32 v30, v30
    v_exp_f32 v31, v31
    v_pk_mul_f32 v[106:107], v[106:107], v[138:139]
    v_exp_f32 v32, v32
    v_exp_f32 v33, v33
    v_pk_mul_f32 v[108:109], v[108:109], v[140:141]
    v_exp_f32 v34, v34
    v_exp_f32 v35, v35
    v_pk_mul_f32 v[110:111], v[110:111], v[142:143]
    v_pk_fma_f32 v[28:29], v[28:29], v[22:23], v[22:23] op_sel:[0,1,1]
    v_pk_fma_f32 v[30:31], v[30:31], v[22:23], v[22:23] op_sel:[0,1,1]
    v_pk_fma_f32 v[32:33], v[32:33], v[22:23], v[22:23] op_sel:[0,1,1]
    v_pk_fma_f32 v[34:35], v[34:35], v[22:23], v[22:23] op_sel:[0,1,1]
    v_rcp_f32 v28, v28
    v_rcp_f32 v29, v29
    v_rcp_f32 v30, v30
    v_rcp_f32 v31, v31
    v_rcp_f32 v32, v32
    v_rcp_f32 v33, v33
    v_rcp_f32 v34, v34
    v_rcp_f32 v35, v35
    v_pk_mul_f32 v[104:105], v[104:105], v[28:29]
    v_pk_mul_f32 v[106:107], v[106:107], v[30:31]
    v_pk_mul_f32 v[108:109], v[108:109], v[32:33]
    v_pk_mul_f32 v[110:111], v[110:111], v[34:35]
    v_cvt_pk_bf16_f32 v136, v104, v105
    v_cvt_pk_bf16_f32 v137, v106, v107
    v_cvt_pk_bf16_f32 v138, v108, v109
    v_cvt_pk_bf16_f32 v139, v110, v111
    ds_write_b128 v5, v[136:139] offset:16640
    v_pk_mul_f32 v[28:29], v[24:25], v[112:113] op_sel_hi:[0,1]
    v_pk_mul_f32 v[30:31], v[24:25], v[114:115] op_sel_hi:[0,1]
    v_pk_mul_f32 v[32:33], v[24:25], v[116:117] op_sel_hi:[0,1]
    v_pk_mul_f32 v[34:35], v[24:25], v[118:119] op_sel_hi:[0,1]
    v_exp_f32 v28, v28
    v_exp_f32 v29, v29
    v_pk_mul_f32 v[112:113], v[112:113], v[144:145]
    v_exp_f32 v30, v30
    v_exp_f32 v31, v31
    v_pk_mul_f32 v[114:115], v[114:115], v[146:147]
    v_exp_f32 v32, v32
    v_exp_f32 v33, v33
    v_pk_mul_f32 v[116:117], v[116:117], v[148:149]
    v_exp_f32 v34, v34
    v_exp_f32 v35, v35
    v_pk_mul_f32 v[118:119], v[118:119], v[150:151]
    v_pk_fma_f32 v[28:29], v[28:29], v[24:25], v[24:25] op_sel:[0,1,1]
    v_pk_fma_f32 v[30:31], v[30:31], v[24:25], v[24:25] op_sel:[0,1,1]
    v_pk_fma_f32 v[32:33], v[32:33], v[24:25], v[24:25] op_sel:[0,1,1]
    v_pk_fma_f32 v[34:35], v[34:35], v[24:25], v[24:25] op_sel:[0,1,1]
    v_rcp_f32 v28, v28
    v_rcp_f32 v29, v29
    v_rcp_f32 v30, v30
    v_rcp_f32 v31, v31
    v_rcp_f32 v32, v32
    v_rcp_f32 v33, v33
    v_rcp_f32 v34, v34
    v_rcp_f32 v35, v35
    v_pk_mul_f32 v[112:113], v[112:113], v[28:29]
    v_pk_mul_f32 v[114:115], v[114:115], v[30:31]
    v_pk_mul_f32 v[116:117], v[116:117], v[32:33]
    v_pk_mul_f32 v[118:119], v[118:119], v[34:35]
    v_cvt_pk_bf16_f32 v144, v112, v113
    v_cvt_pk_bf16_f32 v145, v114, v115
    v_cvt_pk_bf16_f32 v146, v116, v117
    v_cvt_pk_bf16_f32 v147, v118, v119
    ds_write_b128 v5, v[144:147] offset:24576
    v_pk_mul_f32 v[28:29], v[26:27], v[120:121] op_sel_hi:[0,1]
    v_pk_mul_f32 v[30:31], v[26:27], v[122:123] op_sel_hi:[0,1]
    v_pk_mul_f32 v[32:33], v[26:27], v[124:125] op_sel_hi:[0,1]
    v_pk_mul_f32 v[34:35], v[26:27], v[126:127] op_sel_hi:[0,1]
    v_exp_f32 v28, v28
    v_exp_f32 v29, v29
    v_pk_mul_f32 v[120:121], v[120:121], v[152:153]
    v_exp_f32 v30, v30
    v_exp_f32 v31, v31
    v_pk_mul_f32 v[122:123], v[122:123], v[154:155]
    v_exp_f32 v32, v32
    v_exp_f32 v33, v33
    v_pk_mul_f32 v[124:125], v[124:125], v[156:157]
    v_exp_f32 v34, v34
    v_exp_f32 v35, v35
    v_pk_mul_f32 v[126:127], v[126:127], v[158:159]
    v_pk_fma_f32 v[28:29], v[28:29], v[26:27], v[26:27] op_sel:[0,1,1]
    v_pk_fma_f32 v[30:31], v[30:31], v[26:27], v[26:27] op_sel:[0,1,1]
    v_pk_fma_f32 v[32:33], v[32:33], v[26:27], v[26:27] op_sel:[0,1,1]
    v_pk_fma_f32 v[34:35], v[34:35], v[26:27], v[26:27] op_sel:[0,1,1]
    v_rcp_f32 v28, v28
    v_rcp_f32 v29, v29
    v_rcp_f32 v30, v30
    v_rcp_f32 v31, v31
    v_rcp_f32 v32, v32
    v_rcp_f32 v33, v33
    v_rcp_f32 v34, v34
    v_rcp_f32 v35, v35
    v_pk_mul_f32 v[120:121], v[120:121], v[28:29]
    v_pk_mul_f32 v[122:123], v[122:123], v[30:31]
    v_pk_mul_f32 v[124:125], v[124:125], v[32:33]
    v_pk_mul_f32 v[126:127], v[126:127], v[34:35]
    v_cvt_pk_bf16_f32 v152, v120, v121
    v_cvt_pk_bf16_f32 v153, v122, v123
    v_cvt_pk_bf16_f32 v154, v124, v125
    v_cvt_pk_bf16_f32 v155, v126, v127
    ds_write_b128 v5, v[152:155] offset:24832
L_att:
    s_setprio 2
    s_mov_b32 s96, 0x0000ffff
    s_mov_b32 s97, 0x0000ffff
    s_mov_b32 s43, 0
    s_mov_b32 s44, 0x42c00000
    s_mov_b32 s47, 0
    v_mfma_f32_32x32x16_bf16 v[84:99], v[196:199], v[192:195], 0
    v_mfma_f32_32x32x16_bf16 v[100:115], v[196:199], v[208:211], 0
    v_mfma_f32_32x32x16_bf16 v[20:35], v[212:215], v[192:195], 0
    v_mfma_f32_32x32x16_bf16 v[36:51], v[212:215], v[208:211], 0
    ds_read_b32 v6, v7 offset:4
    v_and_b32 v13, 27, v1
    v_cmp_eq_u32 vcc, 16, v13
    v_mov_b32 v15, 130064
    v_mov_b32 v14, 130048
    v_cndmask_b32 v15, v15, v14, vcc
    s_mov_b32 exec_lo, 0x0ff00000
    s_mov_b32 exec_hi, 0x0ff00000
    v_add_u32 v15, 64, v15
    s_mov_b64 exec, -1
    v_mov_b32 v12, 0
    s_mov_b64 exec, s[96:97]
    v_mov_b32 v15, v4
    v_mov_b32 v12, 1
    s_mov_b64 exec, -1
    v_mov_b64 v[52:53], 0
    v_mov_b64 v[54:55], 0
    v_mov_b64 v[56:57], 0
    v_mov_b64 v[58:59], 0
    v_mov_b64 v[60:61], 0
    v_mov_b64 v[62:63], 0
    v_mov_b64 v[64:65], 0
    v_mov_b64 v[66:67], 0
    v_mov_b64 v[68:69], 0
    v_mov_b64 v[70:71], 0
    v_mov_b64 v[72:73], 0
    v_mov_b64 v[74:75], 0
    v_mov_b64 v[76:77], 0
    v_mov_b64 v[78:79], 0
    v_mov_b64 v[80:81], 0
    v_mov_b64 v[82:83], 0
    v_mov_b32 v16, 0xff800000
    v_mov_b32 v17, 0xff800000
    v_max3_f32 v16, v84, v85, v16
    v_max3_f32 v17, v100, v101, v17
    v_max3_f32 v16, v86, v87, v16
    v_max3_f32 v17, v102, v103, v17
    v_max3_f32 v16, v88, v89, v16
    v_max3_f32 v17, v104, v105, v17
    v_max3_f32 v16, v90, v91, v16
    v_max3_f32 v17, v106, v107, v17
    v_max3_f32 v16, v92, v93, v16
    v_max3_f32 v17, v108, v109, v17
    v_max3_f32 v16, v94, v95, v16
    v_max3_f32 v17, v110, v111, v17
    v_max3_f32 v16, v96, v97, v16
    v_max3_f32 v17, v112, v113, v17
    v_max3_f32 v16, v98, v99, v16
    v_max3_f32 v17, v114, v115, v17
    v_max3_f32 v16, v20, v21, v16
    v_max3_f32 v17, v36, v37, v17
    v_max3_f32 v16, v22, v23, v16
    v_max3_f32 v17, v38, v39, v17
    v_max3_f32 v16, v24, v25, v16
    v_max3_f32 v17, v40, v41, v17
    v_max3_f32 v16, v26, v27, v16
    v_max3_f32 v17, v42, v43, v17
    v_max3_f32 v16, v28, v29, v16
    v_max3_f32 v17, v44, v45, v17
    v_max3_f32 v16, v30, v31, v16
    v_max3_f32 v17, v46, v47, v17
    v_max3_f32 v16, v32, v33, v16
    v_max3_f32 v17, v48, v49, v17
    v_max3_f32 v16, v34, v35, v16
    v_max3_f32 v17, v50, v51, v17
L_pass:
    v_mov_b32 v13, v16
    v_mov_b32 v14, v17
    s_mov_b32 s42, 32768
    v_add_u32 v10, s42, v4
    v_mad_u32_u24 v11, s42, v12, v15
    s_cmp_eq_u32 s43, 0
    s_cselect_b32 s46, 0, 7
    s_cselect_b32 s61, 0, 2
    v_permlane32_swap_b32 v16, v13
    v_permlane32_swap_b32 v17, v14
    v_max_f32 v16, v16, v13
    v_max_f32 v17, v17, v14
    v_add_f32 v16, s44, v16
    v_add_f32 v17, s44, v17
    v_sub_f32 v20, 0, v16
    v_sub_f32 v21, 0, v16
    v_mov_b64 v[22:23], v[20:21]
    v_mov_b64 v[24:25], v[20:21]
    v_mov_b64 v[26:27], v[20:21]
    v_mov_b64 v[28:29], v[20:21]
    v_mov_b64 v[30:31], v[20:21]
    v_mov_b64 v[32:33], v[20:21]
    v_mov_b64 v[34:35], v[20:21]
    v_sub_f32 v36, 0, v17
    v_sub_f32 v37, 0, v17
    v_mov_b64 v[38:39], v[36:37]
    v_mov_b64 v[40:41], v[36:37]
    v_mov_b64 v[42:43], v[36:37]
    v_mov_b64 v[44:45], v[36:37]
    v_mov_b64 v[46:47], v[36:37]
    v_mov_b64 v[48:49], v[36:37]
    v_mov_b64 v[50:51], v[36:37]
    s_cbranch_scc0 L_k_ok
L_kw:
    s_waitcnt lgkmcnt(0)
    v_readfirstlane_b32 s47, v6
    s_cmp_ge_u32 s47, 4
    s_cbranch_scc1 L_k_ok
    ds_read_b32 v6, v7 offset:4
    s_sub_u32 s63, s63, 1
    s_cbranch_scc0 L_kw
    s_endpgm
L_k_ok:
    ds_read_b128 v[132:135], v10 offset:0
    s_waitcnt lgkmcnt(0)
    v_mfma_f32_32x32x16_bf16 v[84:99], v[132:135], v[192:195], v[20:35]
    s_nop 11
    v_exp_f32 v84, v84
    v_exp_f32 v85, v85
    v_mfma_f32_32x32x16_bf16 v[100:115], v[132:135], v[208:211], v[36:51]
    ds_read_b128 v[136:139], v10 offset:2048
    v_exp_f32 v86, v86
    v_exp_f32 v87, v87
    v_cvt_pk_bf16_f32 v156, v84, v85
    v_exp_f32 v88, v88
    v_exp_f32 v89, v89
    v_cvt_pk_bf16_f32 v157, v86, v87
    v_exp_f32 v90, v90
    v_exp_f32 v91, v91
    v_cvt_pk_bf16_f32 v158, v88, v89
    v_exp_f32 v92, v92
    v_exp_f32 v93, v93
    v_cvt_pk_bf16_f32 v159, v90, v91
    v_exp_f32 v94, v94
    v_exp_f32 v95, v95
    v_cvt_pk_bf16_f32 v160, v92, v93
    v_exp_f32 v96, v96
    v_exp_f32 v97, v97
    v_cvt_pk_bf16_f32 v161, v94, v95
    v_exp_f32 v98, v98
    v_exp_f32 v99, v99
    v_cvt_pk_bf16_f32 v162, v96, v97
    v_cvt_pk_bf16_f32 v163, v98, v99
    s_waitcnt lgkmcnt(0)
    v_mfma_f32_32x32x16_bf16 v[84:99], v[136:139], v[192:195], v[20:35]
    v_exp_f32 v100, v100
    v_exp_f32 v101, v101
    v_exp_f32 v102, v102
    v_exp_f32 v103, v103
    v_cvt_pk_bf16_f32 v164, v100, v101
    v_exp_f32 v104, v104
    v_exp_f32 v105, v105
    v_cvt_pk_bf16_f32 v165, v102, v103
    v_exp_f32 v106, v106
    v_exp_f32 v107, v107
    v_cvt_pk_bf16_f32 v166, v104, v105
    v_exp_f32 v108, v108
    v_exp_f32 v109, v109
    v_cvt_pk_bf16_f32 v167, v106, v107
    v_exp_f32 v110, v110
    v_exp_f32 v111, v111
    v_cvt_pk_bf16_f32 v168, v108, v109
    v_exp_f32 v112, v112
    v_exp_f32 v113, v113
    v_cvt_pk_bf16_f32 v169, v110, v111
    v_exp_f32 v114, v114
    v_exp_f32 v115, v115
    v_cvt_pk_bf16_f32 v170, v112, v113
    v_cvt_pk_bf16_f32 v171, v114, v115
    v_exp_f32 v84, v84
    v_exp_f32 v85, v85
    v_mfma_f32_32x32x16_bf16 v[100:115], v[136:139], v[208:211], v[36:51]
    ds_read_b128 v[132:135], v10 offset:4096
    v_exp_f32 v86, v86
    v_exp_f32 v87, v87
    v_cvt_pk_bf16_f32 v172, v84, v85
    v_exp_f32 v88, v88
    v_exp_f32 v89, v89
    v_cvt_pk_bf16_f32 v173, v86, v87
    v_exp_f32 v90, v90
    v_exp_f32 v91, v91
    v_cvt_pk_bf16_f32 v174, v88, v89
    v_exp_f32 v92, v92
    v_exp_f32 v93, v93
    v_cvt_pk_bf16_f32 v175, v90, v91
    v_exp_f32 v94, v94
    v_exp_f32 v95, v95
    v_cvt_pk_bf16_f32 v176, v92, v93
    v_exp_f32 v96, v96
    v_exp_f32 v97, v97
    v_cvt_pk_bf16_f32 v177, v94, v95
    v_exp_f32 v98, v98
    v_exp_f32 v99, v99
    v_cvt_pk_bf16_f32 v178, v96, v97
    v_cvt_pk_bf16_f32 v179, v98, v99
    s_waitcnt lgkmcnt(0)
    v_mfma_f32_32x32x16_bf16 v[84:99], v[132:135], v[192:195], v[20:35]
    v_exp_f32 v100, v100
    v_exp_f32 v101, v101
    v_exp_f32 v102, v102
    v_exp_f32 v103, v103
    v_cvt_pk_bf16_f32 v180, v100, v101
    v_exp_f32 v104, v104
    v_exp_f32 v105, v105
    v_cvt_pk_bf16_f32 v181, v102, v103
    v_exp_f32 v106, v106
    v_exp_f32 v107, v107
    v_cvt_pk_bf16_f32 v182, v104, v105
    v_exp_f32 v108, v108
    v_exp_f32 v109, v109
    v_cvt_pk_bf16_f32 v183, v106, v107
    v_exp_f32 v110, v110
    v_exp_f32 v111, v111
    v_cvt_pk_bf16_f32 v184, v108, v109
    v_exp_f32 v112, v112
    v_exp_f32 v113, v113
    v_cvt_pk_bf16_f32 v185, v110, v111
    v_exp_f32 v114, v114
    v_exp_f32 v115, v115
    v_cvt_pk_bf16_f32 v186, v112, v113
    v_cvt_pk_bf16_f32 v187, v114, v115
    v_exp_f32 v84, v84
    v_exp_f32 v85, v85
    v_mfma_f32_32x32x16_bf16 v[100:115], v[132:135], v[208:211], v[36:51]
    ds_read_b128 v[136:139], v10 offset:6144
    v_exp_f32 v86, v86
    v_exp_f32 v87, v87
    v_cvt_pk_bf16_f32 v200, v84, v85
    v_exp_f32 v88, v88
    v_exp_f32 v89, v89
    v_cvt_pk_bf16_f32 v201, v86, v87
    v_exp_f32 v90, v90
    v_exp_f32 v91, v91
    v_cvt_pk_bf16_f32 v202, v88, v89
    v_exp_f32 v92, v92
    v_exp_f32 v93, v93
    v_cvt_pk_bf16_f32 v203, v90, v91
    v_exp_f32 v94, v94
    v_exp_f32 v95, v95
    v_cvt_pk_bf16_f32 v204, v92, v93
    v_exp_f32 v96, v96
    v_exp_f32 v97, v97
    v_cvt_pk_bf16_f32 v205, v94, v95
    v_exp_f32 v98, v98
    v_exp_f32 v99, v99
    v_cvt_pk_bf16_f32 v206, v96, v97
    v_cvt_pk_bf16_f32 v207, v98, v99
    s_waitcnt lgkmcnt(0)
    v_mfma_f32_32x32x16_bf16 v[84:99], v[136:139], v[192:195], v[20:35]
    v_exp_f32 v100, v100
    v_exp_f32 v101, v101
    v_exp_f32 v102, v102
    v_exp_f32 v103, v103
    v_cvt_pk_bf16_f32 v216, v100, v101
    v_exp_f32 v104, v104
    v_exp_f32 v105, v105
    v_cvt_pk_bf16_f32 v217, v102, v103
    v_exp_f32 v106, v106
    v_exp_f32 v107, v107
    v_cvt_pk_bf16_f32 v218, v104, v105
    v_exp_f32 v108, v108
    v_exp_f32 v109, v109
    v_cvt_pk_bf16_f32 v219, v106, v107
    v_exp_f32 v110, v110
    v_exp_f32 v111, v111
    v_cvt_pk_bf16_f32 v220, v108, v109
    v_exp_f32 v112, v112
    v_exp_f32 v113, v113
    v_cvt_pk_bf16_f32 v221, v110, v111
    v_exp_f32 v114, v114
    v_exp_f32 v115, v115
    v_cvt_pk_bf16_f32 v222, v112, v113
    v_cvt_pk_bf16_f32 v223, v114, v115
    v_exp_f32 v84, v84
    v_exp_f32 v85, v85
    v_mfma_f32_32x32x16_bf16 v[100:115], v[136:139], v[208:211], v[36:51]
    ds_read_b128 v[132:135], v10 offset:8192
    v_exp_f32 v86, v86
    v_exp_f32 v87, v87
    v_cvt_pk_bf16_f32 v224, v84, v85
    v_exp_f32 v88, v88
    v_exp_f32 v89, v89
    v_cvt_pk_bf16_f32 v225, v86, v87
    v_exp_f32 v90, v90
    v_exp_f32 v91, v91
    v_cvt_pk_bf16_f32 v226, v88, v89
    v_exp_f32 v92, v92
    v_exp_f32 v93, v93
    v_cvt_pk_bf16_f32 v227, v90, v91
    v_exp_f32 v94, v94
    v_exp_f32 v95, v95
    v_cvt_pk_bf16_f32 v228, v92, v93
    v_exp_f32 v96, v96
    v_exp_f32 v97, v97
    v_cvt_pk_bf16_f32 v229, v94, v95
    v_exp_f32 v98, v98
    v_exp_f32 v99, v99
    v_cvt_pk_bf16_f32 v230, v96, v97
    v_cvt_pk_bf16_f32 v231, v98, v99
    s_waitcnt lgkmcnt(0)
    v_mfma_f32_32x32x16_bf16 v[84:99], v[132:135], v[192:195], v[20:35]
    v_exp_f32 v100, v100
    v_exp_f32 v101, v101
    v_exp_f32 v102, v102
    v_exp_f32 v103, v103
    v_cvt_pk_bf16_f32 v232, v100, v101
    v_exp_f32 v104, v104
    v_exp_f32 v105, v105
    v_cvt_pk_bf16_f32 v233, v102, v103
    v_exp_f32 v106, v106
    v_exp_f32 v107, v107
    v_cvt_pk_bf16_f32 v234, v104, v105
    v_exp_f32 v108, v108
    v_exp_f32 v109, v109
    v_cvt_pk_bf16_f32 v235, v106, v107
    v_exp_f32 v110, v110
    v_exp_f32 v111, v111
    v_cvt_pk_bf16_f32 v236, v108, v109
    v_exp_f32 v112, v112
    v_exp_f32 v113, v113
    v_cvt_pk_bf16_f32 v237, v110, v111
    v_exp_f32 v114, v114
    v_exp_f32 v115, v115
    v_cvt_pk_bf16_f32 v238, v112, v113
    v_cvt_pk_bf16_f32 v239, v114, v115
    s_cmp_lg_u32 s43, 0
    s_cbranch_scc1 L_nob0
    s_barrier
L_nob0:
    ds_read_b128 v[240:243], v11 offset:1024
    ds_read_b128 v[244:247], v11 offset:1280
    v_exp_f32 v84, v84
    v_mfma_f32_32x32x16_bf16 v[100:115], v[132:135], v[208:211], v[36:51]
    ds_read_b128 v[136:139], v10 offset:10240
    ds_read_b128 v[140:143], v11 offset:9216
    ds_read_b128 v[144:147], v11 offset:9472
    ds_read_b128 v[248:251], v11 offset:3072
    ds_read_b128 v[252:255], v11 offset:3328
    v_exp_f32 v85, v85
    v_exp_f32 v86, v86
    v_exp_f32 v87, v87
    v_cvt_pk_bf16_f32 v116, v84, v85
    v_exp_f32 v88, v88
    v_exp_f32 v89, v89
    v_cvt_pk_bf16_f32 v117, v86, v87
    v_exp_f32 v90, v90
    v_exp_f32 v91, v91
    v_cvt_pk_bf16_f32 v118, v88, v89
    s_waitcnt lgkmcnt(5)
    v_mfma_f32_32x32x16_bf16 v[52:67], v[240:243], v[156:159], v[52:67]
    v_exp_f32 v92, v92
    v_exp_f32 v93, v93
    v_cvt_pk_bf16_f32 v119, v90, v91
    v_mfma_f32_32x32x16_bf16 v[52:67], v[244:247], v[160:163], v[52:67]
    v_exp_f32 v94, v94
    v_exp_f32 v95, v95
    v_cvt_pk_bf16_f32 v120, v92, v93
    v_exp_f32 v96, v96
    v_mfma_f32_32x32x16_bf16 v[68:83], v[240:243], v[164:167], v[68:83]
    v_exp_f32 v97, v97
    v_cvt_pk_bf16_f32 v121, v94, v95
    v_exp_f32 v98, v98
    v_mfma_f32_32x32x16_bf16 v[68:83], v[244:247], v[168:171], v[68:83]
    v_exp_f32 v99, v99
    v_cvt_pk_bf16_f32 v122, v96, v97
    v_cvt_pk_bf16_f32 v123, v98, v99
    s_waitcnt lgkmcnt(0)
    v_exp_f32 v100, v100
    v_mfma_f32_32x32x16_bf16 v[52:67], v[140:143], v[116:119], v[52:67]
    ds_read_b128 v[240:243], v11 offset:5120
    ds_read_b128 v[244:247], v11 offset:5376
    ds_read_b128 v[148:151], v11 offset:11264
    ds_read_b128 v[152:155], v11 offset:11520
    v_exp_f32 v101, v101
    v_exp_f32 v102, v102
    v_exp_f32 v103, v103
    v_mfma_f32_32x32x16_bf16 v[84:99], v[136:139], v[192:195], v[20:35]
    v_cvt_pk_bf16_f32 v124, v100, v101
    v_exp_f32 v104, v104
    v_exp_f32 v105, v105
    v_cvt_pk_bf16_f32 v125, v102, v103
    v_mfma_f32_32x32x16_bf16 v[52:67], v[144:147], v[120:123], v[52:67]
    v_exp_f32 v106, v106
    v_exp_f32 v107, v107
    v_cvt_pk_bf16_f32 v126, v104, v105
    v_mfma_f32_32x32x16_bf16 v[52:67], v[248:251], v[172:175], v[52:67]
    v_exp_f32 v108, v108
    v_exp_f32 v109, v109
    v_cvt_pk_bf16_f32 v127, v106, v107
    v_mfma_f32_32x32x16_bf16 v[52:67], v[252:255], v[176:179], v[52:67]
    v_exp_f32 v110, v110
    v_exp_f32 v111, v111
    v_cvt_pk_bf16_f32 v128, v108, v109
    v_exp_f32 v112, v112
    v_mfma_f32_32x32x16_bf16 v[68:83], v[248:251], v[180:183], v[68:83]
    v_exp_f32 v113, v113
    v_cvt_pk_bf16_f32 v129, v110, v111
    v_exp_f32 v114, v114
    v_mfma_f32_32x32x16_bf16 v[68:83], v[252:255], v[184:187], v[68:83]
    v_exp_f32 v115, v115
    v_cvt_pk_bf16_f32 v130, v112, v113
    v_cvt_pk_bf16_f32 v131, v114, v115
    s_waitcnt lgkmcnt(0)
    v_exp_f32 v84, v84
    v_mfma_f32_32x32x16_bf16 v[100:115], v[136:139], v[208:211], v[36:51]
    ds_read_b128 v[132:135], v10 offset:12288
    ds_read_b128 v[248:251], v11 offset:7168
    ds_read_b128 v[252:255], v11 offset:7424
    v_exp_f32 v85, v85
    v_exp_f32 v86, v86
    v_exp_f32 v87, v87
    v_mfma_f32_32x32x16_bf16 v[68:83], v[140:143], v[124:127], v[68:83]
    v_cvt_pk_bf16_f32 v116, v84, v85
    v_exp_f32 v88, v88
    v_exp_f32 v89, v89
    v_cvt_pk_bf16_f32 v117, v86, v87
    v_mfma_f32_32x32x16_bf16 v[68:83], v[144:147], v[128:131], v[68:83]
    ds_read_b128 v[140:143], v11 offset:13312
    ds_read_b128 v[144:147], v11 offset:13568
    v_exp_f32 v90, v90
    v_exp_f32 v91, v91
    v_cvt_pk_bf16_f32 v118, v88, v89
    v_mfma_f32_32x32x16_bf16 v[52:67], v[240:243], v[200:203], v[52:67]
    v_exp_f32 v92, v92
    v_exp_f32 v93, v93
    v_cvt_pk_bf16_f32 v119, v90, v91
    v_mfma_f32_32x32x16_bf16 v[52:67], v[244:247], v[204:207], v[52:67]
    v_exp_f32 v94, v94
    v_exp_f32 v95, v95
    v_cvt_pk_bf16_f32 v120, v92, v93
    v_exp_f32 v96, v96
    v_mfma_f32_32x32x16_bf16 v[68:83], v[240:243], v[216:219], v[68:83]
    v_exp_f32 v97, v97
    v_cvt_pk_bf16_f32 v121, v94, v95
    v_exp_f32 v98, v98
    v_mfma_f32_32x32x16_bf16 v[68:83], v[244:247], v[220:223], v[68:83]
    v_exp_f32 v99, v99
    v_cvt_pk_bf16_f32 v122, v96, v97
    v_cvt_pk_bf16_f32 v123, v98, v99
    s_waitcnt lgkmcnt(2)
    v_exp_f32 v100, v100
    v_mfma_f32_32x32x16_bf16 v[52:67], v[148:151], v[116:119], v[52:67]
    v_exp_f32 v101, v101
    v_exp_f32 v102, v102
    v_exp_f32 v103, v103
    v_mfma_f32_32x32x16_bf16 v[84:99], v[132:135], v[192:195], v[20:35]
    v_cvt_pk_bf16_f32 v124, v100, v101
    v_exp_f32 v104, v104
    v_exp_f32 v105, v105
    v_cvt_pk_bf16_f32 v125, v102, v103
    v_mfma_f32_32x32x16_bf16 v[52:67], v[152:155], v[120:123], v[52:67]
    v_exp_f32 v106, v106
    v_exp_f32 v107, v107
    v_cvt_pk_bf16_f32 v126, v104, v105
    v_mfma_f32_32x32x16_bf16 v[52:67], v[248:251], v[224:227], v[52:67]
    v_exp_f32 v108, v108
    v_exp_f32 v109, v109
    v_cvt_pk_bf16_f32 v127, v106, v107
    v_mfma_f32_32x32x16_bf16 v[52:67], v[252:255], v[228:231], v[52:67]
    v_exp_f32 v110, v110
    v_exp_f32 v111, v111
    v_cvt_pk_bf16_f32 v128, v108, v109
    v_exp_f32 v112, v112
    v_mfma_f32_32x32x16_bf16 v[68:83], v[248:251], v[232:235], v[68:83]
    v_exp_f32 v113, v113
    v_cvt_pk_bf16_f32 v129, v110, v111
    v_exp_f32 v114, v114
    v_mfma_f32_32x32x16_bf16 v[68:83], v[252:255], v[236:239], v[68:83]
    v_exp_f32 v115, v115
    v_cvt_pk_bf16_f32 v130, v112, v113
    v_cvt_pk_bf16_f32 v131, v114, v115
    s_mov_b32 s42, 49152
    s_branch L_entry
.p2align 6
L_aloop:
    v_cvt_pk_bf16_f32 v126, v104, v105
    v_exp_f32 v108, v108
    v_exp_f32 v109, v109
    v_cvt_pk_bf16_f32 v127, v106, v107
    v_exp_f32 v110, v110
    v_exp_f32 v111, v111
    v_cvt_pk_bf16_f32 v128, v108, v109
    v_exp_f32 v112, v112
    v_exp_f32 v113, v113
    v_cvt_pk_bf16_f32 v129, v110, v111
    v_exp_f32 v114, v114
    v_exp_f32 v115, v115
    v_cvt_pk_bf16_f32 v130, v112, v113
    v_cvt_pk_bf16_f32 v131, v114, v115
    v_add_u32 v10, s42, v4
    v_mad_u32_u24 v11, s42, v12, v15
    v_exp_f32 v84, v84
    v_exp_f32 v85, v85
    v_mfma_f32_32x32x16_bf16 v[100:115], v[136:139], v[208:211], v[36:51]
    ds_read_b128 v[132:135], v10 offset:0
    v_exp_f32 v86, v86
    v_exp_f32 v87, v87
    v_cvt_pk_bf16_f32 v116, v84, v85
    v_exp_f32 v88, v88
    v_mfma_f32_32x32x16_bf16 v[68:83], v[140:143], v[124:127], v[68:83]
    s_waitcnt lgkmcnt(1)
    v_exp_f32 v89, v89
    v_cvt_pk_bf16_f32 v117, v86, v87
    v_exp_f32 v90, v90
    v_exp_f32 v91, v91
    v_mfma_f32_32x32x16_bf16 v[68:83], v[144:147], v[128:131], v[68:83]
    ds_read_b128 v[140:143], v11 offset:1024
    ds_read_b128 v[144:147], v11 offset:1280
    v_cvt_pk_bf16_f32 v118, v88, v89
    v_exp_f32 v92, v92
    v_exp_f32 v93, v93
    v_cvt_pk_bf16_f32 v119, v90, v91
    v_exp_f32 v94, v94
    v_exp_f32 v95, v95
    v_cvt_pk_bf16_f32 v120, v92, v93
    v_exp_f32 v96, v96
    v_exp_f32 v97, v97
    v_cvt_pk_bf16_f32 v121, v94, v95
    v_exp_f32 v98, v98
    v_exp_f32 v99, v99
    v_cvt_pk_bf16_f32 v122, v96, v97
    v_cvt_pk_bf16_f32 v123, v98, v99
    v_exp_f32 v100, v100
    v_exp_f32 v101, v101
    v_mfma_f32_32x32x16_bf16 v[52:67], v[148:151], v[116:119], v[52:67]
    s_waitcnt lgkmcnt(2)
    v_exp_f32 v102, v102
    v_exp_f32 v103, v103
    v_cvt_pk_bf16_f32 v124, v100, v101
    v_exp_f32 v104, v104
    v_mfma_f32_32x32x16_bf16 v[84:99], v[132:135], v[192:195], v[20:35]
    s_add_u32 s42, s42, 16384
    v_exp_f32 v105, v105
    v_cvt_pk_bf16_f32 v125, v102, v103
    v_exp_f32 v106, v106
    v_exp_f32 v107, v107
    v_mfma_f32_32x32x16_bf16 v[52:67], v[152:155], v[120:123], v[52:67]
    s_and_b32 s42, s42, 0x1ffff
    v_cvt_pk_bf16_f32 v126, v104, v105
    v_exp_f32 v108, v108
    v_exp_f32 v109, v109
    v_cvt_pk_bf16_f32 v127, v106, v107
    v_exp_f32 v110, v110
    v_exp_f32 v111, v111
    v_cvt_pk_bf16_f32 v128, v108, v109
    v_exp_f32 v112, v112
    v_exp_f32 v113, v113
    v_cvt_pk_bf16_f32 v129, v110, v111
    v_exp_f32 v114, v114
    v_exp_f32 v115, v115
    v_cvt_pk_bf16_f32 v130, v112, v113
    v_cvt_pk_bf16_f32 v131, v114, v115
    v_exp_f32 v84, v84
    v_exp_f32 v85, v85
    v_mfma_f32_32x32x16_bf16 v[100:115], v[132:135], v[208:211], v[36:51]
    ds_read_b128 v[136:139], v10 offset:2048
    v_exp_f32 v86, v86
    v_exp_f32 v87, v87
    v_cvt_pk_bf16_f32 v116, v84, v85
    v_exp_f32 v88, v88
    v_mfma_f32_32x32x16_bf16 v[68:83], v[148:151], v[124:127], v[68:83]
    s_waitcnt lgkmcnt(1)
    v_exp_f32 v89, v89
    v_cvt_pk_bf16_f32 v117, v86, v87
    v_exp_f32 v90, v90
    v_exp_f32 v91, v91
    v_mfma_f32_32x32x16_bf16 v[68:83], v[152:155], v[128:131], v[68:83]
    ds_read_b128 v[148:151], v11 offset:3072
    ds_read_b128 v[152:155], v11 offset:3328
    v_cvt_pk_bf16_f32 v118, v88, v89
    v_exp_f32 v92, v92
    v_exp_f32 v93, v93
    v_cvt_pk_bf16_f32 v119, v90, v91
    v_exp_f32 v94, v94
    v_exp_f32 v95, v95
    v_cvt_pk_bf16_f32 v120, v92, v93
    v_exp_f32 v96, v96
    v_exp_f32 v97, v97
    v_cvt_pk_bf16_f32 v121, v94, v95
    v_exp_f32 v98, v98
    v_exp_f32 v99, v99
    v_cvt_pk_bf16_f32 v122, v96, v97
    v_cvt_pk_bf16_f32 v123, v98, v99
    v_exp_f32 v100, v100
    v_exp_f32 v101, v101
    v_mfma_f32_32x32x16_bf16 v[52:67], v[140:143], v[116:119], v[52:67]
    s_waitcnt lgkmcnt(2)
    v_exp_f32 v102, v102
    v_exp_f32 v103, v103
    v_cvt_pk_bf16_f32 v124, v100, v101
    v_exp_f32 v104, v104
    v_mfma_f32_32x32x16_bf16 v[84:99], v[136:139], v[192:195], v[20:35]
    v_exp_f32 v105, v105
    v_cvt_pk_bf16_f32 v125, v102, v103
    v_exp_f32 v106, v106
    v_exp_f32 v107, v107
    v_mfma_f32_32x32x16_bf16 v[52:67], v[144:147], v[120:123], v[52:67]
    v_cvt_pk_bf16_f32 v126, v104, v105
    v_exp_f32 v108, v108
    v_exp_f32 v109, v109
    v_cvt_pk_bf16_f32 v127, v106, v107
    v_exp_f32 v110, v110
    v_exp_f32 v111, v111
    v_cvt_pk_bf16_f32 v128, v108, v109
    v_exp_f32 v112, v112
    v_exp_f32 v113, v113
    v_cvt_pk_bf16_f32 v129, v110, v111
    v_exp_f32 v114, v114
    v_exp_f32 v115, v115
    v_cvt_pk_bf16_f32 v130, v112, v113
    v_cvt_pk_bf16_f32 v131, v114, v115
    v_exp_f32 v84, v84
    v_exp_f32 v85, v85
    v_mfma_f32_32x32x16_bf16 v[100:115], v[136:139], v[208:211], v[36:51]
    ds_read_b128 v[132:135], v10 offset:4096
    v_exp_f32 v86, v86
    v_exp_f32 v87, v87
    v_cvt_pk_bf16_f32 v116, v84, v85
    v_exp_f32 v88, v88
    v_mfma_f32_32x32x16_bf16 v[68:83], v[140:143], v[124:127], v[68:83]
    s_waitcnt lgkmcnt(1)
    v_exp_f32 v89, v89
    v_cvt_pk_bf16_f32 v117, v86, v87
    v_exp_f32 v90, v90
    v_exp_f32 v91, v91
    v_mfma_f32_32x32x16_bf16 v[68:83], v[144:147], v[128:131], v[68:83]
    ds_read_b128 v[140:143], v11 offset:5120
    ds_read_b128 v[144:147], v11 offset:5376
    v_cvt_pk_bf16_f32 v118, v88, v89
    v_exp_f32 v92, v92
    v_exp_f32 v93, v93
    v_cvt_pk_bf16_f32 v119, v90, v91
    v_exp_f32 v94, v94
    v_exp_f32 v95, v95
    v_cvt_pk_bf16_f32 v120, v92, v93
    v_exp_f32 v96, v96
    v_exp_f32 v97, v97
    v_cvt_pk_bf16_f32 v121, v94, v95
    v_exp_f32 v98, v98
    v_exp_f32 v99, v99
    v_cvt_pk_bf16_f32 v122, v96, v97
    v_cvt_pk_bf16_f32 v123, v98, v99
    v_exp_f32 v100, v100
    v_exp_f32 v101, v101
    v_mfma_f32_32x32x16_bf16 v[52:67], v[148:151], v[116:119], v[52:67]
    s_waitcnt lgkmcnt(2)
    v_exp_f32 v102, v102
    v_exp_f32 v103, v103
    v_cvt_pk_bf16_f32 v124, v100, v101
    v_exp_f32 v104, v104
    v_mfma_f32_32x32x16_bf16 v[84:99], v[132:135], v[192:195], v[20:35]
    v_exp_f32 v105, v105
    v_cvt_pk_bf16_f32 v125, v102, v103
    v_exp_f32 v106, v106
    v_exp_f32 v107, v107
    v_mfma_f32_32x32x16_bf16 v[52:67], v[152:155], v[120:123], v[52:67]
    v_cvt_pk_bf16_f32 v126, v104, v105
    v_exp_f32 v108, v108
    v_exp_f32 v109, v109
    v_cvt_pk_bf16_f32 v127, v106, v107
    v_exp_f32 v110, v110
    v_exp_f32 v111, v111
    v_cvt_pk_bf16_f32 v128, v108, v109
    v_exp_f32 v112, v112
    v_exp_f32 v113, v113
    v_cvt_pk_bf16_f32 v129, v110, v111
    v_exp_f32 v114, v114
    v_exp_f32 v115, v115
    v_cvt_pk_bf16_f32 v130, v112, v113
    v_cvt_pk_bf16_f32 v131, v114, v115
    v_exp_f32 v84, v84
    v_exp_f32 v85, v85
    v_mfma_f32_32x32x16_bf16 v[100:115], v[132:135], v[208:211], v[36:51]
    ds_read_b128 v[136:139], v10 offset:6144
    v_exp_f32 v86, v86
    v_exp_f32 v87, v87
    v_cvt_pk_bf16_f32 v116, v84, v85
    v_exp_f32 v88, v88
    v_mfma_f32_32x32x16_bf16 v[68:83], v[148:151], v[124:127], v[68:83]
    s_waitcnt lgkmcnt(1)
    v_exp_f32 v89, v89
    v_cvt_pk_bf16_f32 v117, v86, v87
    v_exp_f32 v90, v90
    v_exp_f32 v91, v91
    v_mfma_f32_32x32x16_bf16 v[68:83], v[152:155], v[128:131], v[68:83]
    ds_read_b128 v[148:151], v11 offset:7168
    ds_read_b128 v[152:155], v11 offset:7424
    v_cvt_pk_bf16_f32 v118, v88, v89
    v_exp_f32 v92, v92
    v_exp_f32 v93, v93
    v_cvt_pk_bf16_f32 v119, v90, v91
    v_exp_f32 v94, v94
    v_exp_f32 v95, v95
    v_cvt_pk_bf16_f32 v120, v92, v93
    v_exp_f32 v96, v96
    v_exp_f32 v97, v97
    v_cvt_pk_bf16_f32 v121, v94, v95
    v_exp_f32 v98, v98
    v_exp_f32 v99, v99
    v_cvt_pk_bf16_f32 v122, v96, v97
    v_cvt_pk_bf16_f32 v123, v98, v99
    v_exp_f32 v100, v100
    v_exp_f32 v101, v101
    v_mfma_f32_32x32x16_bf16 v[52:67], v[140:143], v[116:119], v[52:67]
    s_waitcnt lgkmcnt(2)
    v_exp_f32 v102, v102
    v_exp_f32 v103, v103
    v_cvt_pk_bf16_f32 v124, v100, v101
    v_exp_f32 v104, v104
    v_mfma_f32_32x32x16_bf16 v[84:99], v[136:139], v[192:195], v[20:35]
    v_exp_f32 v105, v105
    v_cvt_pk_bf16_f32 v125, v102, v103
    v_exp_f32 v106, v106
    v_exp_f32 v107, v107
    v_mfma_f32_32x32x16_bf16 v[52:67], v[144:147], v[120:123], v[52:67]
    v_cvt_pk_bf16_f32 v126, v104, v105
    v_exp_f32 v108, v108
    v_exp_f32 v109, v109
    v_cvt_pk_bf16_f32 v127, v106, v107
    v_exp_f32 v110, v110
    v_exp_f32 v111, v111
    v_cvt_pk_bf16_f32 v128, v108, v109
    v_exp_f32 v112, v112
    v_exp_f32 v113, v113
    v_cvt_pk_bf16_f32 v129, v110, v111
    v_exp_f32 v114, v114
    v_exp_f32 v115, v115
    v_cvt_pk_bf16_f32 v130, v112, v113
    v_cvt_pk_bf16_f32 v131, v114, v115
    v_exp_f32 v84, v84
    v_exp_f32 v85, v85
    v_mfma_f32_32x32x16_bf16 v[100:115], v[136:139], v[208:211], v[36:51]
    ds_read_b128 v[132:135], v10 offset:8192
    v_exp_f32 v86, v86
    v_exp_f32 v87, v87
    v_cvt_pk_bf16_f32 v116, v84, v85
    v_exp_f32 v88, v88
    v_mfma_f32_32x32x16_bf16 v[68:83], v[140:143], v[124:127], v[68:83]
    s_waitcnt lgkmcnt(1)
    v_exp_f32 v89, v89
    v_cvt_pk_bf16_f32 v117, v86, v87
    v_exp_f32 v90, v90
    v_exp_f32 v91, v91
    v_mfma_f32_32x32x16_bf16 v[68:83], v[144:147], v[128:131], v[68:83]
    ds_read_b128 v[140:143], v11 offset:9216
    ds_read_b128 v[144:147], v11 offset:9472
    v_cvt_pk_bf16_f32 v118, v88, v89
    v_exp_f32 v92, v92
    v_exp_f32 v93, v93
    v_cvt_pk_bf16_f32 v119, v90, v91
    v_exp_f32 v94, v94
    v_exp_f32 v95, v95
    v_cvt_pk_bf16_f32 v120, v92, v93
    v_exp_f32 v96, v96
    v_exp_f32 v97, v97
    v_cvt_pk_bf16_f32 v121, v94, v95
    v_exp_f32 v98, v98
    v_exp_f32 v99, v99
    v_cvt_pk_bf16_f32 v122, v96, v97
    v_cvt_pk_bf16_f32 v123, v98, v99
    v_exp_f32 v100, v100
    v_exp_f32 v101, v101
    v_mfma_f32_32x32x16_bf16 v[52:67], v[148:151], v[116:119], v[52:67]
    s_waitcnt lgkmcnt(2)
    v_exp_f32 v102, v102
    v_exp_f32 v103, v103
    v_cvt_pk_bf16_f32 v124, v100, v101
    v_exp_f32 v104, v104
    v_mfma_f32_32x32x16_bf16 v[84:99], v[132:135], v[192:195], v[20:35]
    v_exp_f32 v105, v105
    v_cvt_pk_bf16_f32 v125, v102, v103
    v_exp_f32 v106, v106
    v_exp_f32 v107, v107
    v_mfma_f32_32x32x16_bf16 v[52:67], v[152:155], v[120:123], v[52:67]
    v_cvt_pk_bf16_f32 v126, v104, v105
    v_exp_f32 v108, v108
    v_exp_f32 v109, v109
    v_cvt_pk_bf16_f32 v127, v106, v107
    v_exp_f32 v110, v110
    v_exp_f32 v111, v111
    v_cvt_pk_bf16_f32 v128, v108, v109
    v_exp_f32 v112, v112
    v_exp_f32 v113, v113
    v_cvt_pk_bf16_f32 v129, v110, v111
    v_exp_f32 v114, v114
    v_exp_f32 v115, v115
    v_cvt_pk_bf16_f32 v130, v112, v113
    v_cvt_pk_bf16_f32 v131, v114, v115
    v_exp_f32 v84, v84
    v_exp_f32 v85, v85
    v_mfma_f32_32x32x16_bf16 v[100:115], v[132:135], v[208:211], v[36:51]
    ds_read_b128 v[136:139], v10 offset:10240
    v_exp_f32 v86, v86
    v_exp_f32 v87, v87
    v_cvt_pk_bf16_f32 v116, v84, v85
    v_exp_f32 v88, v88
    v_mfma_f32_32x32x16_bf16 v[68:83], v[148:151], v[124:127], v[68:83]
    s_waitcnt lgkmcnt(1)
    v_exp_f32 v89, v89
    v_cvt_pk_bf16_f32 v117, v86, v87
    v_exp_f32 v90, v90
    v_exp_f32 v91, v91
    v_mfma_f32_32x32x16_bf16 v[68:83], v[152:155], v[128:131], v[68:83]
    ds_read_b128 v[148:151], v11 offset:11264
    ds_read_b128 v[152:155], v11 offset:11520
    v_cvt_pk_bf16_f32 v118, v88, v89
    v_exp_f32 v92, v92
    v_exp_f32 v93, v93
    v_cvt_pk_bf16_f32 v119, v90, v91
    v_exp_f32 v94, v94
    v_exp_f32 v95, v95
    v_cvt_pk_bf16_f32 v120, v92, v93
    v_exp_f32 v96, v96
    v_exp_f32 v97, v97
    v_cvt_pk_bf16_f32 v121, v94, v95
    v_exp_f32 v98, v98
    v_exp_f32 v99, v99
    v_cvt_pk_bf16_f32 v122, v96, v97
    v_cvt_pk_bf16_f32 v123, v98, v99
    v_exp_f32 v100, v100
    v_exp_f32 v101, v101
    v_mfma_f32_32x32x16_bf16 v[52:67], v[140:143], v[116:119], v[52:67]
    s_waitcnt lgkmcnt(2)
    v_exp_f32 v102, v102
    v_exp_f32 v103, v103
    v_cvt_pk_bf16_f32 v124, v100, v101
    v_exp_f32 v104, v104
    v_mfma_f32_32x32x16_bf16 v[84:99], v[136:139], v[192:195], v[20:35]
    v_exp_f32 v105, v105
    v_cvt_pk_bf16_f32 v125, v102, v103
    v_exp_f32 v106, v106
    v_exp_f32 v107, v107
    v_mfma_f32_32x32x16_bf16 v[52:67], v[144:147], v[120:123], v[52:67]
    v_cvt_pk_bf16_f32 v126, v104, v105
    v_exp_f32 v108, v108
    v_exp_f32 v109, v109
    v_cvt_pk_bf16_f32 v127, v106, v107
    v_exp_f32 v110, v110
    v_exp_f32 v111, v111
    v_cvt_pk_bf16_f32 v128, v108, v109
    v_exp_f32 v112, v112
    v_exp_f32 v113, v113
    v_cvt_pk_bf16_f32 v129, v110, v111
    v_exp_f32 v114, v114
    v_exp_f32 v115, v115
    v_cvt_pk_bf16_f32 v130, v112, v113
    v_cvt_pk_bf16_f32 v131, v114, v115
    v_exp_f32 v84, v84
    v_exp_f32 v85, v85
    v_mfma_f32_32x32x16_bf16 v[100:115], v[136:139], v[208:211], v[36:51]
    ds_read_b128 v[132:135], v10 offset:12288
    v_exp_f32 v86, v86
    v_exp_f32 v87, v87
    v_cvt_pk_bf16_f32 v116, v84, v85
    v_exp_f32 v88, v88
    v_mfma_f32_32x32x16_bf16 v[68:83], v[140:143], v[124:127], v[68:83]
    s_waitcnt lgkmcnt(1)
    v_exp_f32 v89, v89
    v_cvt_pk_bf16_f32 v117, v86, v87
    v_exp_f32 v90, v90
    v_exp_f32 v91, v91
    v_mfma_f32_32x32x16_bf16 v[68:83], v[144:147], v[128:131], v[68:83]
    ds_read_b128 v[140:143], v11 offset:13312
    ds_read_b128 v[144:147], v11 offset:13568
    v_cvt_pk_bf16_f32 v118, v88, v89
    v_exp_f32 v92, v92
    v_exp_f32 v93, v93
    v_cvt_pk_bf16_f32 v119, v90, v91
    v_exp_f32 v94, v94
    v_exp_f32 v95, v95
    v_cvt_pk_bf16_f32 v120, v92, v93
    v_exp_f32 v96, v96
    v_exp_f32 v97, v97
    v_cvt_pk_bf16_f32 v121, v94, v95
    v_exp_f32 v98, v98
    v_exp_f32 v99, v99
    v_cvt_pk_bf16_f32 v122, v96, v97
    v_cvt_pk_bf16_f32 v123, v98, v99
    v_exp_f32 v100, v100
    v_exp_f32 v101, v101
    v_mfma_f32_32x32x16_bf16 v[52:67], v[148:151], v[116:119], v[52:67]
    s_waitcnt lgkmcnt(2)
    v_exp_f32 v102, v102
    v_exp_f32 v103, v103
    v_cvt_pk_bf16_f32 v124, v100, v101
    v_exp_f32 v104, v104
    v_mfma_f32_32x32x16_bf16 v[84:99], v[132:135], v[192:195], v[20:35]
    v_exp_f32 v105, v105
    v_cvt_pk_bf16_f32 v125, v102, v103
    v_exp_f32 v106, v106
    v_exp_f32 v107, v107
    v_mfma_f32_32x32x16_bf16 v[52:67], v[152:155], v[120:123], v[52:67]
    v_cvt_pk_bf16_f32 v126, v104, v105
    v_exp_f32 v108, v108
    v_exp_f32 v109, v109
    v_cvt_pk_bf16_f32 v127, v106, v107
    v_exp_f32 v110, v110
    v_exp_f32 v111, v111
    v_cvt_pk_bf16_f32 v128, v108, v109
    v_exp_f32 v112, v112
    v_exp_f32 v113, v113
    v_cvt_pk_bf16_f32 v129, v110, v111
    v_exp_f32 v114, v114
    v_exp_f32 v115, v115
    v_cvt_pk_bf16_f32 v130, v112, v113
    v_cvt_pk_bf16_f32 v131, v114, v115
L_entry:
    v_exp_f32 v84, v84
    v_exp_f32 v85, v85
    v_mfma_f32_32x32x16_bf16 v[100:115], v[132:135], v[208:211], v[36:51]
    ds_read_b128 v[136:139], v10 offset:14336
    v_exp_f32 v86, v86
    v_exp_f32 v87, v87
    v_cvt_pk_bf16_f32 v116, v84, v85
    v_exp_f32 v88, v88
    v_mfma_f32_32x32x16_bf16 v[68:83], v[148:151], v[124:127], v[68:83]
    s_waitcnt lgkmcnt(1)
    v_exp_f32 v89, v89
    v_cvt_pk_bf16_f32 v117, v86, v87
    v_exp_f32 v90, v90
    v_exp_f32 v91, v91
    v_mfma_f32_32x32x16_bf16 v[68:83], v[152:155], v[128:131], v[68:83]
    ds_read_b128 v[148:151], v11 offset:15360
    ds_read_b128 v[152:155], v11 offset:15616
    v_cvt_pk_bf16_f32 v118, v88, v89
    v_exp_f32 v92, v92
    v_exp_f32 v93, v93
    v_cvt_pk_bf16_f32 v119, v90, v91
    v_exp_f32 v94, v94
    v_exp_f32 v95, v95
    v_cvt_pk_bf16_f32 v120, v92, v93
    v_exp_f32 v96, v96
    v_exp_f32 v97, v97
    v_cvt_pk_bf16_f32 v121, v94, v95
    v_exp_f32 v98, v98
    v_exp_f32 v99, v99
    v_cvt_pk_bf16_f32 v122, v96, v97
    v_cvt_pk_bf16_f32 v123, v98, v99
    v_exp_f32 v100, v100
    v_exp_f32 v101, v101
    v_mfma_f32_32x32x16_bf16 v[52:67], v[140:143], v[116:119], v[52:67]
    s_waitcnt lgkmcnt(2)
    v_exp_f32 v102, v102
    v_exp_f32 v103, v103
    v_cvt_pk_bf16_f32 v124, v100, v101
    v_exp_f32 v104, v104
    v_mfma_f32_32x32x16_bf16 v[84:99], v[136:139], v[192:195], v[20:35]
    s_sub_u32 s46, s46, 1
    v_exp_f32 v105, v105
    v_cvt_pk_bf16_f32 v125, v102, v103
    v_exp_f32 v106, v106
    v_exp_f32 v107, v107
    v_mfma_f32_32x32x16_bf16 v[52:67], v[144:147], v[120:123], v[52:67]
    s_cbranch_scc0 L_aloop
    s_cmp_eq_u32 s61, 2
    s_cbranch_scc1 L_aloop_done
    s_cmp_eq_u32 s61, 0
    s_cselect_b32 s46, 1, 4
    s_add_u32 s61, s61, 1
    s_cmp_eq_u32 s61, 2
    s_cbranch_scc1 L_b2
    s_barrier
    s_branch L_aloop
L_b2:
L_b2w:
    ds_read_b32 v6, v7 offset:8
    s_sub_u32 s63, s63, 1
    s_cbranch_scc1 L_end
    s_waitcnt lgkmcnt(0)
    v_readfirstlane_b32 s47, v6
    s_cmp_ge_u32 s47, 4
    s_cbranch_scc1 L_aloop
    s_branch L_b2w
L_aloop_done:
    v_cvt_pk_bf16_f32 v126, v104, v105
    v_exp_f32 v108, v108
    v_exp_f32 v109, v109
    v_cvt_pk_bf16_f32 v127, v106, v107
    v_exp_f32 v110, v110
    v_exp_f32 v111, v111
    v_cvt_pk_bf16_f32 v128, v108, v109
    v_exp_f32 v112, v112
    v_exp_f32 v113, v113
    v_cvt_pk_bf16_f32 v129, v110, v111
    v_exp_f32 v114, v114
    v_exp_f32 v115, v115
    v_cvt_pk_bf16_f32 v130, v112, v113
    v_cvt_pk_bf16_f32 v131, v114, v115
    v_add_u32 v10, s42, v4
    v_mad_u32_u24 v11, s42, v12, v15
    v_exp_f32 v84, v84
    v_exp_f32 v85, v85
    v_mfma_f32_32x32x16_bf16 v[100:115], v[136:139], v[208:211], v[36:51]
    ds_read_b128 v[132:135], v10 offset:0
    v_exp_f32 v86, v86
    v_exp_f32 v87, v87
    v_cvt_pk_bf16_f32 v116, v84, v85
    v_exp_f32 v88, v88
    v_mfma_f32_32x32x16_bf16 v[68:83], v[140:143], v[124:127], v[68:83]
    s_waitcnt lgkmcnt(1)
    v_exp_f32 v89, v89
    v_cvt_pk_bf16_f32 v117, v86, v87
    v_exp_f32 v90, v90
    v_exp_f32 v91, v91
    v_mfma_f32_32x32x16_bf16 v[68:83], v[144:147], v[128:131], v[68:83]
    ds_read_b128 v[140:143], v11 offset:1024
    ds_read_b128 v[144:147], v11 offset:1280
    v_cvt_pk_bf16_f32 v118, v88, v89
    v_exp_f32 v92, v92
    v_exp_f32 v93, v93
    v_cvt_pk_bf16_f32 v119, v90, v91
    v_exp_f32 v94, v94
    v_exp_f32 v95, v95
    v_cvt_pk_bf16_f32 v120, v92, v93
    v_exp_f32 v96, v96
    v_exp_f32 v97, v97
    v_cvt_pk_bf16_f32 v121, v94, v95
    v_exp_f32 v98, v98
    v_exp_f32 v99, v99
    v_cvt_pk_bf16_f32 v122, v96, v97
    v_cvt_pk_bf16_f32 v123, v98, v99
    v_exp_f32 v100, v100
    v_exp_f32 v101, v101
    v_mfma_f32_32x32x16_bf16 v[52:67], v[148:151], v[116:119], v[52:67]
    s_waitcnt lgkmcnt(2)
    v_exp_f32 v102, v102
    v_exp_f32 v103, v103
    v_cvt_pk_bf16_f32 v124, v100, v101
    v_exp_f32 v104, v104
    v_mfma_f32_32x32x16_bf16 v[84:99], v[132:135], v[192:195], v[20:35]
    s_add_u32 s42, s42, 16384
    v_exp_f32 v105, v105
    v_cvt_pk_bf16_f32 v125, v102, v103
    v_exp_f32 v106, v106
    v_exp_f32 v107, v107
    v_mfma_f32_32x32x16_bf16 v[52:67], v[152:155], v[120:123], v[52:67]
    s_and_b32 s42, s42, 0x1ffff
    v_cvt_pk_bf16_f32 v126, v104, v105
    v_exp_f32 v108, v108
    v_exp_f32 v109, v109
    v_cvt_pk_bf16_f32 v127, v106, v107
    v_exp_f32 v110, v110
    v_exp_f32 v111, v111
    v_cvt_pk_bf16_f32 v128, v108, v109
    v_exp_f32 v112, v112
    v_exp_f32 v113, v113
    v_cvt_pk_bf16_f32 v129, v110, v111
    v_exp_f32 v114, v114
    v_exp_f32 v115, v115
    v_cvt_pk_bf16_f32 v130, v112, v113
    v_cvt_pk_bf16_f32 v131, v114, v115
    s_nop 0
    v_mfma_f32_32x32x16_bf16 v[68:83], v[148:151], v[124:127], v[68:83]
    v_mfma_f32_32x32x16_bf16 v[68:83], v[152:155], v[128:131], v[68:83]
    s_lshl_b32 s47, s36, 2
    s_add_u32 s47, s47, 159760
    v_mov_b32 v10, s47
    ds_read_b32 v12, v10
    s_mov_b32 s45, 0x76800000
    v_rcp_f32 v16, v60
    v_add_f32 v13, abs(v52), v60
    v_add_f32 v13, abs(v53), v13
    v_add_f32 v13, abs(v54), v13
    v_add_f32 v13, abs(v55), v13
    v_add_f32 v13, abs(v56), v13
    v_add_f32 v13, abs(v57), v13
    v_add_f32 v13, abs(v58), v13
    v_add_f32 v13, abs(v59), v13
    s_nop 1
    v_rcp_f32 v17, v76
    v_add_f32 v13, abs(v68), v13
    v_add_f32 v13, abs(v69), v13
    v_add_f32 v13, abs(v70), v13
    v_add_f32 v13, abs(v71), v13
    v_add_f32 v13, abs(v72), v13
    v_add_f32 v13, abs(v73), v13
    v_add_f32 v13, abs(v74), v13
    v_add_f32 v13, abs(v75), v13
    v_add_f32 v13, abs(v76), v13
    v_cmp_ngt_f32 vcc, s45, v13
    s_cmp_lg_u32 s43, 0
    s_cbranch_scc1 L_store
    s_cmp_eq_u64 vcc, 0
    s_cbranch_scc0 L_redo
L_store:
    s_waitcnt lgkmcnt(0)
    v_readfirstlane_b32 s47, v12
    s_cmp_eq_u32 s47, 0
    s_cbranch_scc1 L_owait
    v_pk_mul_f32 v[52:53], v[52:53], v[16:17] op_sel_hi:[1,0]
    v_pk_mul_f32 v[54:55], v[54:55], v[16:17] op_sel_hi:[1,0]
    v_pk_mul_f32 v[56:57], v[56:57], v[16:17] op_sel_hi:[1,0]
    v_pk_mul_f32 v[58:59], v[58:59], v[16:17] op_sel_hi:[1,0]
    v_cvt_pk_bf16_f32 v116, v52, v53
    v_cvt_pk_bf16_f32 v117, v54, v55
    v_cvt_pk_bf16_f32 v118, v56, v57
    v_cvt_pk_bf16_f32 v119, v58, v59
    buffer_store_dwordx4 v[116:119], v4, s[28:31], s39 offen sc1
    v_pk_mul_f32 v[68:69], v[68:69], v[16:17] op_sel:[0,1]
    v_pk_mul_f32 v[70:71], v[70:71], v[16:17] op_sel:[0,1]
    v_pk_mul_f32 v[72:73], v[72:73], v[16:17] op_sel:[0,1]
    v_pk_mul_f32 v[74:75], v[74:75], v[16:17] op_sel:[0,1]
    v_cvt_pk_bf16_f32 v124, v68, v69
    v_cvt_pk_bf16_f32 v125, v70, v71
    v_cvt_pk_bf16_f32 v126, v72, v73
    v_cvt_pk_bf16_f32 v127, v74, v75
    buffer_store_dwordx4 v[124:127], v4, s[28:31], s40 offen sc1
    s_endpgm
L_owait:
    s_sleep 8
    ds_read_b32 v12, v10
    s_sub_u32 s63, s63, 1
    s_cbranch_scc0 L_store
    s_endpgm
L_redo:
    s_mov_b32 s43, 1
    s_mov_b32 s47, 31
    s_mov_b32 s44, 0
    s_waitcnt lgkmcnt(0)
    v_and_b32 v13, 27, v1
    v_cmp_eq_u32 vcc, 16, v13
    v_mov_b32 v15, 130064
    v_mov_b32 v14, 130048
    v_cndmask_b32 v15, v15, v14, vcc
    s_mov_b32 exec_lo, 0x0ff00000
    s_mov_b32 exec_hi, 0x0ff00000
    v_add_u32 v15, 64, v15
    s_mov_b64 exec, -1
    v_mov_b32 v12, 0
    s_mov_b64 exec, s[96:97]
    v_mov_b32 v15, v4
    v_mov_b32 v12, 1
    s_mov_b64 exec, -1
    v_mov_b64 v[52:53], 0
    v_mov_b64 v[54:55], 0
    v_mov_b64 v[56:57], 0
    v_mov_b64 v[58:59], 0
    v_mov_b64 v[60:61], 0
    v_mov_b64 v[62:63], 0
    v_mov_b64 v[64:65], 0
    v_mov_b64 v[66:67], 0
    v_mov_b64 v[68:69], 0
    v_mov_b64 v[70:71], 0
    v_mov_b64 v[72:73], 0
    v_mov_b64 v[74:75], 0
    v_mov_b64 v[76:77], 0
    v_mov_b64 v[78:79], 0
    v_mov_b64 v[80:81], 0
    v_mov_b64 v[82:83], 0
    v_mov_b32 v10, v4
    v_mov_b32 v16, 0xff800000
    v_mov_b32 v17, 0xff800000
L_maxloop:
    ds_read_b128 v[132:135], v10
    ds_read_b128 v[136:139], v10 offset:2048
    v_add_u32 v10, 4096, v10
    s_waitcnt lgkmcnt(0)
    v_mfma_f32_32x32x16_bf16 v[84:99], v[132:135], v[192:195], 0
    v_mfma_f32_32x32x16_bf16 v[100:115], v[132:135], v[208:211], 0
    v_mfma_f32_32x32x16_bf16 v[20:35], v[136:139], v[192:195], 0
    v_mfma_f32_32x32x16_bf16 v[36:51], v[136:139], v[208:211], 0
    s_nop 8
    v_max3_f32 v16, v84, v85, v16
    v_max3_f32 v17, v100, v101, v17
    v_max3_f32 v16, v86, v87, v16
    v_max3_f32 v17, v102, v103, v17
    v_max3_f32 v16, v88, v89, v16
    v_max3_f32 v17, v104, v105, v17
    v_max3_f32 v16, v90, v91, v16
    v_max3_f32 v17, v106, v107, v17
    v_max3_f32 v16, v92, v93, v16
    v_max3_f32 v17, v108, v109, v17
    v_max3_f32 v16, v94, v95, v16
    v_max3_f32 v17, v110, v111, v17
    v_max3_f32 v16, v96, v97, v16
    v_max3_f32 v17, v112, v113, v17
    v_max3_f32 v16, v98, v99, v16
    v_max3_f32 v17, v114, v115, v17
    v_max3_f32 v16, v20, v21, v16
    v_max3_f32 v17, v36, v37, v17
    v_max3_f32 v16, v22, v23, v16
    v_max3_f32 v17, v38, v39, v17
    v_max3_f32 v16, v24, v25, v16
    v_max3_f32 v17, v40, v41, v17
    v_max3_f32 v16, v26, v27, v16
    v_max3_f32 v17, v42, v43, v17
    v_max3_f32 v16, v28, v29, v16
    v_max3_f32 v17, v44, v45, v17
    v_max3_f32 v16, v30, v31, v16
    v_max3_f32 v17, v46, v47, v17
    v_max3_f32 v16, v32, v33, v16
    v_max3_f32 v17, v48, v49, v17
    v_max3_f32 v16, v34, v35, v16
    v_max3_f32 v17, v50, v51, v17
    s_sub_u32 s47, s47, 1
    s_cbranch_scc0 L_maxloop
    s_branch L_pass
L_h_done:
    s_waitcnt lgkmcnt(0)
    s_barrier
    s_lshr_b32 s40, s2, 5
    s_and_b32 s43, s2, 7
    s_lshl_b32 s43, s43, 2
    s_bfe_u32 s47, s2, 0x20003
    s_add_u32 s43, s43, s47
    s_lshl_b32 s96, s43, 1
    s_lshr_b32 s47, s36, 1
    s_add_u32 s96, s96, s47
    s_lshl_b32 s97, s40, 1
    s_and_b32 s47, s36, 1
    s_add_u32 s97, s97, s47
    s_lshl_b32 s61, s96, 15
    s_lshl_b32 s47, s97, 6
    s_add_u32 s61, s61, s47
    s_mov_b64 exec, 65535
    ds_write_b128 v21, v[40:43] offset:0
    ds_write_b128 v21, v[32:35] offset:16
    ds_write_b128 v21, v[40:43] offset:64
    ds_write_b128 v21, v[32:35] offset:80
    s_mov_b64 exec, -1
    s_mov_b32 s44, 23592960
    s_lshl_b32 s39, s38, 16
    s_add_u32 s39, s39, 2097152
    s_lshl_b32 s62, s37, 13
    s_lshl_b32 s47, s36, 10
    s_add_u32 s62, s62, s47
    s_lshl_b32 s46, s37, 2
    s_add_u32 s46, s46, s36
    s_lshl_b32 s48, s38, 2
    s_lshl_b32 s47, s38, 1
    s_add_u32 s47, s47, 46
    s_cmp_lt_u32 s38, 24
    s_cselect_b32 s48, s48, s47
    s_mul_i32 s49, s46, 224
    s_add_u32 s49, s49, s48
    s_lshl_b32 s49, s49, 10
    s_add_u32 s49, s49, 8388608
    s_add_u32 s50, s49, 114688
    s_lshl_b32 s51, s46, 16
    s_lshl_b32 s48, s38, 10
    s_add_u32 s51, s51, s48
    s_add_u32 s51, s51, 6291456
    s_add_u32 s60, s51, 0x8000
    s_lshl_b32 s46, s36, 11
    s_waitcnt lgkmcnt(0)
    s_cmp_lg_u32 s36, 0
    s_cbranch_scc1 L_b0
    s_mov_b64 exec, 0x607
L_p0:
    buffer_load_dwordx4 v[32:35], v14, s[28:31], s44 offen sc1
    s_sub_u32 s63, s63, 1
    s_cbranch_scc1 L_end
    s_waitcnt vmcnt(0)
    v_xor_b32 v32, v3, v32
    v_xor_b32 v33, v3, v33
    v_xor_b32 v34, v3, v34
    v_xor_b32 v35, v3, v35
    v_or3_b32 v32, v32, v33, v34
    v_or_b32 v32, v32, v35
    v_cmp_ne_u32 vcc, 0, v32
    s_nop 0
    s_cmp_eq_u64 vcc, 0
    s_cselect_b32 s45, 2, 1
    s_bitcmp0_b32 vcc_lo, 0
    s_cbranch_scc1 L_p0_ok
    s_sleep 4
    s_branch L_p0
L_p0_ok:
    s_mov_b64 exec, -1
    s_add_u32 s42, s39, s62
    s_add_u32 s42, s42, 2097152
    s_mov_b32 m0, 33792
    s_nop 0
    buffer_load_dwordx4 v4, s[28:31], s42 offen offset:0 sc1 lds
    s_mov_b32 m0, 34816
    s_nop 0
    buffer_load_dwordx4 v4, s[28:31], s42 offen offset:1024 sc1 lds
    s_mov_b32 m0, 35840
    s_nop 0
    buffer_load_dwordx4 v4, s[28:31], s42 offen offset:2048 sc1 lds
    s_mov_b32 m0, 36864
    s_nop 0
    buffer_load_dwordx4 v4, s[28:31], s42 offen offset:3072 sc1 lds
    s_mov_b32 m0, 41984
    s_add_u32 s42, s42, 4096
    buffer_load_dwordx4 v4, s[28:31], s42 offen offset:0 sc1 lds
    s_mov_b32 m0, 43008
    s_nop 0
    buffer_load_dwordx4 v4, s[28:31], s42 offen offset:1024 sc1 lds
    s_mov_b32 m0, 44032
    s_nop 0
    buffer_load_dwordx4 v4, s[28:31], s42 offen offset:2048 sc1 lds
    s_mov_b32 m0, 45056
    s_nop 0
    buffer_load_dwordx4 v4, s[28:31], s42 offen offset:3072 sc1 lds
    v_mov_b32 v16, s45
    ds_write_b32 v18, v16
    s_cmp_lt_u32 s45, 2
    s_cbranch_scc1 L_v_only
L_rf:
    ds_read_b32 v16, v18 offset:4
    s_sub_u32 s63, s63, 1
    s_cbranch_scc1 L_end
    s_waitcnt lgkmcnt(0)
    s_nop 0
    v_readfirstlane_b32 s47, v16
    s_cmp_ge_u32 s47, 4
    s_cbranch_scc1 L_rf_ok
    s_sleep 1
    s_branch L_rf
L_rf_ok:
    s_mov_b32 s47, 3
L_b1all:
    s_add_u32 s41, s62, 8192
    s_and_b32 s41, s41, 0xffff
    s_add_u32 s41, s41, s39
    s_add_u32 m0, s46, 49152
    s_add_u32 s42, s41, 2096128
    buffer_load_dwordx4 v4, s[28:31], s41 offen sc1 lds
    buffer_load_dwordx4 v4, s[28:31], s42 offen offset:1024 sc1 lds
    s_add_u32 s41, s62, 12288
    s_and_b32 s41, s41, 0xffff
    s_add_u32 s41, s41, s39
    s_add_u32 m0, s46, 57344
    s_add_u32 s42, s41, 2096128
    buffer_load_dwordx4 v4, s[28:31], s41 offen sc1 lds
    buffer_load_dwordx4 v4, s[28:31], s42 offen offset:1024 sc1 lds
    s_add_u32 s41, s62, 16384
    s_and_b32 s41, s41, 0xffff
    s_add_u32 s41, s41, s39
    s_add_u32 m0, s46, 65536
    s_add_u32 s42, s41, 2096128
    buffer_load_dwordx4 v4, s[28:31], s41 offen sc1 lds
    buffer_load_dwordx4 v4, s[28:31], s42 offen offset:1024 sc1 lds
    s_add_u32 s41, s62, 20480
    s_and_b32 s41, s41, 0xffff
    s_add_u32 s41, s41, s39
    s_add_u32 m0, s46, 73728
    s_add_u32 s42, s41, 2096128
    buffer_load_dwordx4 v4, s[28:31], s41 offen sc1 lds
    buffer_load_dwordx4 v4, s[28:31], s42 offen offset:1024 sc1 lds
    s_add_u32 s62, s62, 1024
    s_add_u32 s46, s46, 2048
    s_sub_u32 s47, s47, 1
    s_cbranch_scc0 L_b1all
    s_sub_u32 s62, s62, 4096
    s_mov_b32 s46, 0
    s_waitcnt vmcnt(32)
    s_branch L_b0w
L_v_only:
    s_waitcnt vmcnt(0)
L_b0w:
    s_waitcnt lgkmcnt(0)
L_b0:
    s_barrier
    ds_read_b32 v16, v18
    s_waitcnt lgkmcnt(0)
    v_readfirstlane_b32 s47, v16
    s_cmp_ge_u32 s47, 2
    s_cbranch_scc1 L_fast
    s_mov_b32 exec_lo, 1542
    s_mov_b32 exec_hi, 0
L_kv2:
    buffer_load_dwordx4 v[32:35], v14, s[28:31], s44 offen sc1
    s_sub_u32 s63, s63, 1
    s_cbranch_scc1 L_end
L_kv2_c:
    s_waitcnt vmcnt(0)
    v_xor_b32 v32, v3, v32
    v_xor_b32 v33, v3, v33
    v_xor_b32 v34, v3, v34
    v_xor_b32 v35, v3, v35
    v_or3_b32 v32, v32, v33, v34
    v_or_b32 v32, v32, v35
    v_cmp_ne_u32 vcc, 0, v32
    s_nop 0
    s_cmp_eq_u64 vcc, 0
    s_cbranch_scc1 L_kv2_ok
    s_sleep 4
    s_branch L_kv2
L_kv2_ok:
    s_mov_b64 exec, -1
    s_add_u32 s41, s62, 8192
    s_and_b32 s41, s41, 0xffff
    s_add_u32 s41, s41, s39
    s_add_u32 m0, s46, 49152
    s_add_u32 s42, s41, 2096128
    buffer_load_dwordx4 v4, s[28:31], s41 offen sc1 lds
    buffer_load_dwordx4 v4, s[28:31], s42 offen offset:1024 sc1 lds
    s_add_u32 s41, s62, 12288
    s_and_b32 s41, s41, 0xffff
    s_add_u32 s41, s41, s39
    s_add_u32 m0, s46, 57344
    s_add_u32 s42, s41, 2096128
    buffer_load_dwordx4 v4, s[28:31], s41 offen sc1 lds
    buffer_load_dwordx4 v4, s[28:31], s42 offen offset:1024 sc1 lds
    s_add_u32 s41, s62, 16384
    s_and_b32 s41, s41, 0xffff
    s_add_u32 s41, s41, s39
    s_add_u32 m0, s46, 65536
    s_add_u32 s42, s41, 2096128
    buffer_load_dwordx4 v4, s[28:31], s41 offen sc1 lds
    buffer_load_dwordx4 v4, s[28:31], s42 offen offset:1024 sc1 lds
    s_add_u32 s41, s62, 20480
    s_and_b32 s41, s41, 0xffff
    s_add_u32 s41, s41, s39
    s_add_u32 m0, s46, 73728
    s_add_u32 s42, s41, 2096128
    buffer_load_dwordx4 v4, s[28:31], s41 offen sc1 lds
    buffer_load_dwordx4 v4, s[28:31], s42 offen offset:1024 sc1 lds
L_fast:
    s_mov_b64 exec, 0xf8f8
    buffer_load_dwordx4 v[32:35], v14, s[28:31], s44 offen sc1
    s_mov_b64 exec, -1
    ds_read_b128 v[192:195], v10 offset:0
    ds_read_b128 v[196:199], v10 offset:1024
    ds_read_b128 v[200:203], v10 offset:8192
    ds_read_b128 v[204:207], v10 offset:9216
    ds_read_b128 v[208:211], v10 offset:16384
    ds_read_b128 v[212:215], v10 offset:17408
    ds_read_b128 v[216:219], v10 offset:24576
    ds_read_b128 v[220:223], v10 offset:25600
    s_waitcnt vmcnt(1)
    s_and_b32 s47, s2, 15
    s_mul_i32 s47, s47, 9
    s_add_u32 s47, s47, s36
    s_add_u32 s47, s47, 0
    s_cmp_lt_u32 s47, 32
    s_cselect_b64 s[4:5], s[8:9], s[10:11]
    s_cselect_b32 s48, 0, 32
    s_mov_b32 s6, 524288
    s_cselect_b32 s6, s6, 1835008
    s_sub_u32 s47, s47, s48
    s_lshl_b32 s47, s47, 14
    s_lshr_b32 s48, s2, 4
    s_lshl_b32 s48, s48, 6
    s_add_u32 s47, s47, s48
    s_mul_i32 s48, s36, 3072
    s_add_u32 m0, s48, 147456
    s_nop 0
    buffer_load_dwordx4 v22, s[4:7], s47 offen lds
    s_and_b32 s47, s2, 15
    s_mul_i32 s47, s47, 9
    s_add_u32 s47, s47, s36
    s_add_u32 s47, s47, 4
    s_cmp_lt_u32 s47, 32
    s_cselect_b64 s[4:5], s[8:9], s[10:11]
    s_cselect_b32 s48, 0, 32
    s_mov_b32 s6, 524288
    s_cselect_b32 s6, s6, 1835008
    s_sub_u32 s47, s47, s48
    s_lshl_b32 s47, s47, 14
    s_lshr_b32 s48, s2, 4
    s_lshl_b32 s48, s48, 6
    s_add_u32 s47, s47, s48
    s_mul_i32 s48, s36, 3072
    s_add_u32 m0, s48, 148480
    s_nop 0
    buffer_load_dwordx4 v22, s[4:7], s47 offen lds
    s_and_b32 s47, s2, 15
    s_mul_i32 s47, s47, 9
    s_add_u32 s47, s47, 8
    s_cmp_lt_u32 s47, 32
    s_cselect_b64 s[4:5], s[8:9], s[10:11]
    s_cselect_b32 s48, 0, 32
    s_mov_b32 s6, 524288
    s_cselect_b32 s6, s6, 1835008
    s_sub_u32 s47, s47, s48
    s_lshl_b32 s47, s47, 14
    s_lshr_b32 s48, s2, 4
    s_lshl_b32 s48, s48, 6
    s_add_u32 s47, s47, s48
    s_mul_i32 s48, s36, 3072
    s_add_u32 m0, s48, 149504
    s_nop 0
    buffer_load_dwordx4 v22, s[4:7], s47 offen lds
    s_barrier
    s_setprio 3
    s_mov_b32 exec_lo, 63736
    s_mov_b32 exec_hi, 0
    s_branch L_kv3_c
L_kv3:
    buffer_load_dwordx4 v[32:35], v14, s[28:31], s44 offen sc1
    s_sub_u32 s63, s63, 1
    s_cbranch_scc1 L_end
L_kv3_c:
    s_waitcnt vmcnt(0)
    v_xor_b32 v32, v3, v32
    v_xor_b32 v33, v3, v33
    v_xor_b32 v34, v3, v34
    v_xor_b32 v35, v3, v35
    v_or3_b32 v32, v32, v33, v34
    v_or_b32 v32, v32, v35
    v_cmp_ne_u32 vcc, 0, v32
    s_nop 0
    s_cmp_eq_u64 vcc, 0
    s_cbranch_scc1 L_kv3_ok
    s_sleep 4
    s_branch L_kv3
L_kv3_ok:
    s_mov_b64 exec, -1
    ds_read_b64_tr_b16 v[44:45], v20 offset:0
    ds_read_b64_tr_b16 v[46:47], v20 offset:512
    ds_read_b64_tr_b16 v[48:49], v20 offset:1024
    ds_read_b64_tr_b16 v[50:51], v20 offset:1536
    ds_read_b64_tr_b16 v[52:53], v20 offset:2048
    ds_read_b64_tr_b16 v[54:55], v20 offset:2560
    s_waitcnt lgkmcnt(0)
    s_add_u32 s41, s62, 24576
    s_and_b32 s41, s41, 0xffff
    s_add_u32 s41, s41, s39
    s_add_u32 m0, s46, 81920
    s_add_u32 s42, s41, 2096128
    buffer_load_dwordx4 v4, s[28:31], s41 offen sc1 lds
    buffer_load_dwordx4 v4, s[28:31], s42 offen offset:1024 sc1 lds
    s_add_u32 s41, s62, 28672
    s_and_b32 s41, s41, 0xffff
    s_add_u32 s41, s41, s39
    s_add_u32 m0, s46, 90112
    s_add_u32 s42, s41, 2096128
    buffer_load_dwordx4 v4, s[28:31], s41 offen sc1 lds
    buffer_load_dwordx4 v4, s[28:31], s42 offen offset:1024 sc1 lds
    s_add_u32 s41, s62, 32768
    s_and_b32 s41, s41, 0xffff
    s_add_u32 s41, s41, s39
    s_add_u32 m0, s46, 98304
    s_add_u32 s42, s41, 2096128
    buffer_load_dwordx4 v4, s[28:31], s41 offen sc1 lds
    buffer_load_dwordx4 v4, s[28:31], s42 offen offset:1024 sc1 lds
    s_add_u32 s41, s62, 36864
    s_and_b32 s41, s41, 0xffff
    s_add_u32 s41, s41, s39
    s_add_u32 m0, s46, 106496
    s_add_u32 s42, s41, 2096128
    buffer_load_dwordx4 v4, s[28:31], s41 offen sc1 lds
    buffer_load_dwordx4 v4, s[28:31], s42 offen offset:1024 sc1 lds
    s_add_u32 s41, s62, 40960
    s_and_b32 s41, s41, 0xffff
    s_add_u32 s41, s41, s39
    s_add_u32 m0, s46, 114688
    s_add_u32 s42, s41, 2096128
    buffer_load_dwordx4 v4, s[28:31], s41 offen sc1 lds
    buffer_load_dwordx4 v4, s[28:31], s42 offen offset:1024 sc1 lds
    s_add_u32 s41, s62, 45056
    s_and_b32 s41, s41, 0xffff
    s_add_u32 s41, s41, s39
    s_add_u32 m0, s46, 122880
    s_add_u32 s42, s41, 2096128
    buffer_load_dwordx4 v4, s[28:31], s41 offen sc1 lds
    buffer_load_dwordx4 v4, s[28:31], s42 offen offset:1024 sc1 lds
    s_add_u32 s41, s62, 49152
    s_and_b32 s41, s41, 0xffff
    s_add_u32 s41, s41, s39
    s_add_u32 m0, s46, 0
    s_add_u32 s42, s41, 2096128
    buffer_load_dwordx4 v4, s[28:31], s41 offen sc1 lds
    buffer_load_dwordx4 v4, s[28:31], s42 offen offset:1024 sc1 lds
    s_add_u32 s41, s62, 53248
    s_and_b32 s41, s41, 0xffff
    s_add_u32 s41, s41, s39
    s_add_u32 m0, s46, 8192
    s_add_u32 s42, s41, 2096128
    buffer_load_dwordx4 v4, s[28:31], s41 offen sc1 lds
    buffer_load_dwordx4 v4, s[28:31], s42 offen offset:1024 sc1 lds
    s_add_u32 s41, s62, 57344
    s_and_b32 s41, s41, 0xffff
    s_add_u32 s41, s41, s39
    s_add_u32 m0, s46, 16384
    s_add_u32 s42, s41, 2096128
    buffer_load_dwordx4 v4, s[28:31], s41 offen sc1 lds
    buffer_load_dwordx4 v4, s[28:31], s42 offen offset:1024 sc1 lds
    s_add_u32 s41, s62, 61440
    s_and_b32 s41, s41, 0xffff
    s_add_u32 s41, s41, s39
    s_add_u32 m0, s46, 24576
    s_add_u32 s42, s41, 2096128
    buffer_load_dwordx4 v4, s[28:31], s41 offen sc1 lds
    buffer_load_dwordx4 v4, s[28:31], s42 offen offset:1024 sc1 lds
    buffer_store_dwordx4 v[36:39], v4, s[28:31], s51 offen sc1
    buffer_store_dwordx4 v[36:39], v4, s[28:31], s60 offen sc1
    s_mul_i32 s47, s2, 9
    s_add_u32 s47, s47, s36
    s_add_u32 s47, s47, 0
    s_lshl_b32 s47, s47, 10
    s_add_u32 s47, s47, 15728640
    buffer_store_dwordx4 v[44:47], v4, s[28:31], s47 offen sc1
    s_mul_i32 s47, s2, 9
    s_add_u32 s47, s47, s36
    s_add_u32 s47, s47, 4
    s_lshl_b32 s47, s47, 10
    s_add_u32 s47, s47, 15728640
    buffer_store_dwordx4 v[48:51], v4, s[28:31], s47 offen sc1
    s_mul_i32 s47, s2, 9
    s_add_u32 s47, s47, 8
    s_lshl_b32 s47, s47, 10
    s_add_u32 s47, s47, 15728640
    buffer_store_dwordx4 v[52:55], v4, s[28:31], s47 offen sc1
    buffer_store_dwordx4 v[192:195], v4, s[28:31], s49 offen offset:2048 sc1
    buffer_store_dwordx4 v[196:199], v4, s[28:31], s49 offen offset:3072 sc1
    buffer_store_dwordx4 v[200:203], v4, s[28:31], s50 offen offset:2048 sc1
    buffer_store_dwordx4 v[204:207], v4, s[28:31], s50 offen offset:3072 sc1
    s_waitcnt vmcnt(9)
    s_mov_b64 exec, 1
    ds_add_u32 v18, v8 offset:8
    s_mov_b64 exec, -1
    s_cmp_ge_u32 s38, 24
    s_cbranch_scc1 L_hs_d
    buffer_store_dwordx4 v[208:211], v4, s[28:31], s49 offen offset:0 sc1
    buffer_store_dwordx4 v[212:215], v4, s[28:31], s49 offen offset:1024 sc1
    buffer_store_dwordx4 v[216:219], v4, s[28:31], s50 offen offset:0 sc1
    buffer_store_dwordx4 v[220:223], v4, s[28:31], s50 offen offset:1024 sc1
L_hs_d:
    s_lshl_b32 s45, s40, 12
    s_add_u32 s45, s45, 23134208
    s_lshl_b32 s44, s2, 5
    s_add_u32 s44, s44, s36
    s_lshl_b32 s44, s44, 2
    s_add_u32 s44, s44, 23134208
    s_lshl_b32 s46, s38, 3
    s_add_u32 s46, s46, s37
    s_lshl_b32 s46, s46, 6
    s_add_u32 s46, s46, s36
    s_lshl_b32 s46, s46, 2
    s_add_u32 s46, s46, 23593088
    s_lshl_b32 s47, s36, 2
    v_add_u32 v5, s47, v18
    s_waitcnt vmcnt(0)
    s_mov_b64 exec, 1
    buffer_store_dword v3, v2, s[28:31], s44 offen sc1
    buffer_store_dword v3, v2, s[28:31], s46 offen sc1
    ds_write_b32 v5, v8 offset:16
    s_mov_b64 exec, -1
    s_mul_i32 s48, s36, 28672
    s_xor_b32 s47, s96, 0
    s_mul_i32 s49, s47, 114688
    s_add_u32 s49, s49, s48
    s_add_u32 s49, s49, 8388608
    s_xor_b32 s47, s97, 0
    s_mul_i32 s51, s47, 147456
    s_add_u32 s51, s51, s48
    s_add_u32 s51, s51, 15761408
    s_xor_b32 s47, s96, 1
    s_mul_i32 s50, s47, 114688
    s_add_u32 s50, s50, s48
    s_add_u32 s50, s50, 8388608
    s_xor_b32 s47, s97, 1
    s_mul_i32 s60, s47, 147456
    s_add_u32 s60, s60, s48
    s_add_u32 s60, s60, 15761408
    s_lshr_b32 s44, s43, 2
    s_lshl_b32 s44, s44, 8
    s_and_b32 s47, s43, 3
    s_lshl_b32 s47, s47, 2
    s_add_u32 s44, s44, s47
    s_add_u32 s44, s44, 23593088
    s_add_u32 s0, s61, 0x4000
    buffer_load_dwordx4 v[56:59], v13, s[20:23], s61 offen
    buffer_load_dwordx4 v[60:63], v13, s[20:23], s0 offen
    s_waitcnt vmcnt(0)
    v_permlane16_swap_b32 v56, v58
    v_permlane16_swap_b32 v57, v59
    v_permlane16_swap_b32 v60, v62
    v_permlane16_swap_b32 v61, v63
    v_lshlrev_b32 v64, 16, v56
    v_and_b32 v65, 0xffff0000, v56
    v_lshlrev_b32 v66, 16, v57
    v_and_b32 v67, 0xffff0000, v57
    v_lshlrev_b32 v68, 16, v58
    v_and_b32 v69, 0xffff0000, v58
    v_lshlrev_b32 v70, 16, v59
    v_and_b32 v71, 0xffff0000, v59
    v_lshlrev_b32 v72, 16, v60
    v_and_b32 v73, 0xffff0000, v60
    v_lshlrev_b32 v74, 16, v61
    v_and_b32 v75, 0xffff0000, v61
    v_lshlrev_b32 v76, 16, v62
    v_and_b32 v77, 0xffff0000, v62
    v_lshlrev_b32 v78, 16, v63
    v_and_b32 v79, 0xffff0000, v63
    s_cmp_lg_u32 s36, 0
    s_cbranch_scc1 L_h_o
    s_mov_b32 exec_lo, -1
    s_mov_b32 exec_hi, 0
L_p4:
    buffer_load_dwordx4 v[32:35], v17, s[28:31], s45 offen sc1
    s_sub_u32 s63, s63, 1
    s_cbranch_scc1 L_end
L_p4_c:
    s_waitcnt vmcnt(0)
    v_xor_b32 v32, v3, v32
    v_xor_b32 v33, v3, v33
    v_xor_b32 v34, v3, v34
    v_xor_b32 v35, v3, v35
    v_or3_b32 v32, v32, v33, v34
    v_or_b32 v32, v32, v35
    v_cmp_ne_u32 vcc, 0, v32
    s_nop 0
    s_cmp_eq_u64 vcc, 0
    s_cbranch_scc1 L_p4_ok
    s_sleep 6
    s_branch L_p4
L_p4_ok:
    s_mov_b64 exec, -1
    s_mov_b32 exec_lo, -1
    s_mov_b32 exec_hi, 0
L_h_p0:
    buffer_load_dword v16, v15, s[28:31], s44 offen sc1
    s_sub_u32 s63, s63, 1
    s_cbranch_scc1 L_end
    s_waitcnt vmcnt(0)
    v_cmp_ne_u32 vcc, v3, v16
    s_nop 0
    s_cmp_eq_u64 vcc, 0
    s_cbranch_scc1 L_h_p0_ok
    s_sleep 6
    s_branch L_h_p0
L_h_p0_ok:
    s_mov_b64 exec, -1
    v_mov_b32 v16, 3
    ds_write_b32 v18, v16
    s_branch L_h_d
L_h_o:
L_h_w:
    ds_read_b32 v16, v18 offset:0
    s_sub_u32 s63, s63, 1
    s_cbranch_scc1 L_end
    s_waitcnt lgkmcnt(0)
    s_nop 0
    v_readfirstlane_b32 s47, v16
    s_cmp_ge_u32 s47, 3
    s_cbranch_scc1 L_h_w_ok
    s_sleep 6
    s_branch L_h_w
L_h_w_ok:
L_h_d:
    s_setprio 0
    buffer_load_dwordx4 v[128:131], v23, s[28:31], s49 offen offset:0 sc1
    buffer_load_dwordx4 v[132:135], v23, s[28:31], s49 offen offset:256 sc1
    buffer_load_dwordx4 v[136:139], v23, s[28:31], s50 offen offset:0 sc1
    buffer_load_dwordx4 v[140:143], v23, s[28:31], s50 offen offset:256 sc1
    buffer_load_dwordx4 v[144:147], v23, s[28:31], s51 offen offset:0 sc1
    buffer_load_dwordx4 v[148:151], v23, s[28:31], s51 offen offset:256 sc1
    buffer_load_dwordx4 v[152:155], v23, s[28:31], s60 offen offset:0 sc1
    buffer_load_dwordx4 v[156:159], v23, s[28:31], s60 offen offset:256 sc1
    buffer_load_dwordx4 v[160:163], v23, s[28:31], s49 offen offset:2048 sc1
    buffer_load_dwordx4 v[164:167], v23, s[28:31], s49 offen offset:2304 sc1
    buffer_load_dwordx4 v[168:171], v23, s[28:31], s50 offen offset:2048 sc1
    buffer_load_dwordx4 v[172:175], v23, s[28:31], s50 offen offset:2304 sc1
    buffer_load_dwordx4 v[176:179], v23, s[28:31], s51 offen offset:2048 sc1
    buffer_load_dwordx4 v[180:183], v23, s[28:31], s51 offen offset:2304 sc1
    buffer_load_dwordx4 v[184:187], v23, s[28:31], s60 offen offset:2048 sc1
    buffer_load_dwordx4 v[188:191], v23, s[28:31], s60 offen offset:2304 sc1
    s_add_u32 s49, s49, 4096
    s_add_u32 s50, s50, 4096
    s_add_u32 s51, s51, 4096
    s_add_u32 s60, s60, 4096
    buffer_load_dwordx4 v[192:195], v23, s[28:31], s49 offen offset:0 sc1
    buffer_load_dwordx4 v[196:199], v23, s[28:31], s49 offen offset:256 sc1
    buffer_load_dwordx4 v[200:203], v23, s[28:31], s50 offen offset:0 sc1
    buffer_load_dwordx4 v[204:207], v23, s[28:31], s50 offen offset:256 sc1
    buffer_load_dwordx4 v[208:211], v23, s[28:31], s51 offen offset:0 sc1
    buffer_load_dwordx4 v[212:215], v23, s[28:31], s51 offen offset:256 sc1
    buffer_load_dwordx4 v[216:219], v23, s[28:31], s60 offen offset:0 sc1
    buffer_load_dwordx4 v[220:223], v23, s[28:31], s60 offen offset:256 sc1
    buffer_load_dwordx4 v[224:227], v23, s[28:31], s49 offen offset:2048 sc1
    buffer_load_dwordx4 v[228:231], v23, s[28:31], s49 offen offset:2304 sc1
    buffer_load_dwordx4 v[232:235], v23, s[28:31], s50 offen offset:2048 sc1
    buffer_load_dwordx4 v[236:239], v23, s[28:31], s50 offen offset:2304 sc1
    buffer_load_dwordx4 v[240:243], v23, s[28:31], s51 offen offset:2048 sc1
    buffer_load_dwordx4 v[244:247], v23, s[28:31], s51 offen offset:2304 sc1
    buffer_load_dwordx4 v[248:251], v23, s[28:31], s60 offen offset:2048 sc1
    buffer_load_dwordx4 v[252:255], v23, s[28:31], s60 offen offset:2304 sc1
    s_add_u32 s49, s49, 4096
    s_add_u32 s50, s50, 4096
    s_add_u32 s51, s51, 4096
    s_add_u32 s60, s60, 4096
    s_mov_b32 s46, 1
L_gloop:
    s_waitcnt vmcnt(16)
    v_mfma_f32_16x16x32_bf16 v[64:67], v[144:147], v[128:131], v[64:67]
    v_mfma_f32_16x16x32_bf16 v[64:67], v[176:179], v[160:163], v[64:67]
    v_mfma_f32_16x16x32_bf16 v[68:71], v[148:151], v[128:131], v[68:71]
    v_mfma_f32_16x16x32_bf16 v[68:71], v[180:183], v[160:163], v[68:71]
    v_mfma_f32_16x16x32_bf16 v[80:83], v[152:155], v[128:131], v[80:83]
    v_mfma_f32_16x16x32_bf16 v[80:83], v[184:187], v[160:163], v[80:83]
    v_mfma_f32_16x16x32_bf16 v[84:87], v[156:159], v[128:131], v[84:87]
    v_mfma_f32_16x16x32_bf16 v[84:87], v[188:191], v[160:163], v[84:87]
    v_mfma_f32_16x16x32_bf16 v[72:75], v[144:147], v[132:135], v[72:75]
    v_mfma_f32_16x16x32_bf16 v[72:75], v[176:179], v[164:167], v[72:75]
    v_mfma_f32_16x16x32_bf16 v[76:79], v[148:151], v[132:135], v[76:79]
    v_mfma_f32_16x16x32_bf16 v[76:79], v[180:183], v[164:167], v[76:79]
    v_mfma_f32_16x16x32_bf16 v[88:91], v[152:155], v[132:135], v[88:91]
    v_mfma_f32_16x16x32_bf16 v[88:91], v[184:187], v[164:167], v[88:91]
    v_mfma_f32_16x16x32_bf16 v[92:95], v[156:159], v[132:135], v[92:95]
    v_mfma_f32_16x16x32_bf16 v[92:95], v[188:191], v[164:167], v[92:95]
    v_mfma_f32_16x16x32_bf16 v[96:99], v[144:147], v[136:139], v[96:99]
    v_mfma_f32_16x16x32_bf16 v[96:99], v[176:179], v[168:171], v[96:99]
    v_mfma_f32_16x16x32_bf16 v[100:103], v[148:151], v[136:139], v[100:103]
    v_mfma_f32_16x16x32_bf16 v[100:103], v[180:183], v[168:171], v[100:103]
    v_mfma_f32_16x16x32_bf16 v[112:115], v[152:155], v[136:139], v[112:115]
    v_mfma_f32_16x16x32_bf16 v[112:115], v[184:187], v[168:171], v[112:115]
    v_mfma_f32_16x16x32_bf16 v[116:119], v[156:159], v[136:139], v[116:119]
    v_mfma_f32_16x16x32_bf16 v[116:119], v[188:191], v[168:171], v[116:119]
    v_mfma_f32_16x16x32_bf16 v[104:107], v[144:147], v[140:143], v[104:107]
    v_mfma_f32_16x16x32_bf16 v[104:107], v[176:179], v[172:175], v[104:107]
    v_mfma_f32_16x16x32_bf16 v[108:111], v[148:151], v[140:143], v[108:111]
    v_mfma_f32_16x16x32_bf16 v[108:111], v[180:183], v[172:175], v[108:111]
    v_mfma_f32_16x16x32_bf16 v[120:123], v[152:155], v[140:143], v[120:123]
    v_mfma_f32_16x16x32_bf16 v[120:123], v[184:187], v[172:175], v[120:123]
    v_mfma_f32_16x16x32_bf16 v[124:127], v[156:159], v[140:143], v[124:127]
    v_mfma_f32_16x16x32_bf16 v[124:127], v[188:191], v[172:175], v[124:127]
    buffer_load_dwordx4 v[128:131], v23, s[28:31], s49 offen offset:0 sc1
    buffer_load_dwordx4 v[132:135], v23, s[28:31], s49 offen offset:256 sc1
    buffer_load_dwordx4 v[136:139], v23, s[28:31], s50 offen offset:0 sc1
    buffer_load_dwordx4 v[140:143], v23, s[28:31], s50 offen offset:256 sc1
    buffer_load_dwordx4 v[144:147], v23, s[28:31], s51 offen offset:0 sc1
    buffer_load_dwordx4 v[148:151], v23, s[28:31], s51 offen offset:256 sc1
    buffer_load_dwordx4 v[152:155], v23, s[28:31], s60 offen offset:0 sc1
    buffer_load_dwordx4 v[156:159], v23, s[28:31], s60 offen offset:256 sc1
    buffer_load_dwordx4 v[160:163], v23, s[28:31], s49 offen offset:2048 sc1
    buffer_load_dwordx4 v[164:167], v23, s[28:31], s49 offen offset:2304 sc1
    buffer_load_dwordx4 v[168:171], v23, s[28:31], s50 offen offset:2048 sc1
    buffer_load_dwordx4 v[172:175], v23, s[28:31], s50 offen offset:2304 sc1
    buffer_load_dwordx4 v[176:179], v23, s[28:31], s51 offen offset:2048 sc1
    buffer_load_dwordx4 v[180:183], v23, s[28:31], s51 offen offset:2304 sc1
    buffer_load_dwordx4 v[184:187], v23, s[28:31], s60 offen offset:2048 sc1
    buffer_load_dwordx4 v[188:191], v23, s[28:31], s60 offen offset:2304 sc1
    s_add_u32 s49, s49, 4096
    s_add_u32 s50, s50, 4096
    s_add_u32 s51, s51, 4096
    s_add_u32 s60, s60, 4096
    s_waitcnt vmcnt(16)
    v_mfma_f32_16x16x32_bf16 v[64:67], v[208:211], v[192:195], v[64:67]
    v_mfma_f32_16x16x32_bf16 v[64:67], v[240:243], v[224:227], v[64:67]
    v_mfma_f32_16x16x32_bf16 v[68:71], v[212:215], v[192:195], v[68:71]
    v_mfma_f32_16x16x32_bf16 v[68:71], v[244:247], v[224:227], v[68:71]
    v_mfma_f32_16x16x32_bf16 v[80:83], v[216:219], v[192:195], v[80:83]
    v_mfma_f32_16x16x32_bf16 v[80:83], v[248:251], v[224:227], v[80:83]
    v_mfma_f32_16x16x32_bf16 v[84:87], v[220:223], v[192:195], v[84:87]
    v_mfma_f32_16x16x32_bf16 v[84:87], v[252:255], v[224:227], v[84:87]
    v_mfma_f32_16x16x32_bf16 v[72:75], v[208:211], v[196:199], v[72:75]
    v_mfma_f32_16x16x32_bf16 v[72:75], v[240:243], v[228:231], v[72:75]
    v_mfma_f32_16x16x32_bf16 v[76:79], v[212:215], v[196:199], v[76:79]
    v_mfma_f32_16x16x32_bf16 v[76:79], v[244:247], v[228:231], v[76:79]
    v_mfma_f32_16x16x32_bf16 v[88:91], v[216:219], v[196:199], v[88:91]
    v_mfma_f32_16x16x32_bf16 v[88:91], v[248:251], v[228:231], v[88:91]
    v_mfma_f32_16x16x32_bf16 v[92:95], v[220:223], v[196:199], v[92:95]
    v_mfma_f32_16x16x32_bf16 v[92:95], v[252:255], v[228:231], v[92:95]
    v_mfma_f32_16x16x32_bf16 v[96:99], v[208:211], v[200:203], v[96:99]
    v_mfma_f32_16x16x32_bf16 v[96:99], v[240:243], v[232:235], v[96:99]
    v_mfma_f32_16x16x32_bf16 v[100:103], v[212:215], v[200:203], v[100:103]
    v_mfma_f32_16x16x32_bf16 v[100:103], v[244:247], v[232:235], v[100:103]
    v_mfma_f32_16x16x32_bf16 v[112:115], v[216:219], v[200:203], v[112:115]
    v_mfma_f32_16x16x32_bf16 v[112:115], v[248:251], v[232:235], v[112:115]
    v_mfma_f32_16x16x32_bf16 v[116:119], v[220:223], v[200:203], v[116:119]
    v_mfma_f32_16x16x32_bf16 v[116:119], v[252:255], v[232:235], v[116:119]
    v_mfma_f32_16x16x32_bf16 v[104:107], v[208:211], v[204:207], v[104:107]
    v_mfma_f32_16x16x32_bf16 v[104:107], v[240:243], v[236:239], v[104:107]
    v_mfma_f32_16x16x32_bf16 v[108:111], v[212:215], v[204:207], v[108:111]
    v_mfma_f32_16x16x32_bf16 v[108:111], v[244:247], v[236:239], v[108:111]
    v_mfma_f32_16x16x32_bf16 v[120:123], v[216:219], v[204:207], v[120:123]
    v_mfma_f32_16x16x32_bf16 v[120:123], v[248:251], v[236:239], v[120:123]
    v_mfma_f32_16x16x32_bf16 v[124:127], v[220:223], v[204:207], v[124:127]
    v_mfma_f32_16x16x32_bf16 v[124:127], v[252:255], v[236:239], v[124:127]
    buffer_load_dwordx4 v[192:195], v23, s[28:31], s49 offen offset:0 sc1
    buffer_load_dwordx4 v[196:199], v23, s[28:31], s49 offen offset:256 sc1
    buffer_load_dwordx4 v[200:203], v23, s[28:31], s50 offen offset:0 sc1
    buffer_load_dwordx4 v[204:207], v23, s[28:31], s50 offen offset:256 sc1
    buffer_load_dwordx4 v[208:211], v23, s[28:31], s51 offen offset:0 sc1
    buffer_load_dwordx4 v[212:215], v23, s[28:31], s51 offen offset:256 sc1
    buffer_load_dwordx4 v[216:219], v23, s[28:31], s60 offen offset:0 sc1
    buffer_load_dwordx4 v[220:223], v23, s[28:31], s60 offen offset:256 sc1
    buffer_load_dwordx4 v[224:227], v23, s[28:31], s49 offen offset:2048 sc1
    buffer_load_dwordx4 v[228:231], v23, s[28:31], s49 offen offset:2304 sc1
    buffer_load_dwordx4 v[232:235], v23, s[28:31], s50 offen offset:2048 sc1
    buffer_load_dwordx4 v[236:239], v23, s[28:31], s50 offen offset:2304 sc1
    buffer_load_dwordx4 v[240:243], v23, s[28:31], s51 offen offset:2048 sc1
    buffer_load_dwordx4 v[244:247], v23, s[28:31], s51 offen offset:2304 sc1
    buffer_load_dwordx4 v[248:251], v23, s[28:31], s60 offen offset:2048 sc1
    buffer_load_dwordx4 v[252:255], v23, s[28:31], s60 offen offset:2304 sc1
    s_add_u32 s49, s49, 4096
    s_add_u32 s50, s50, 4096
    s_add_u32 s51, s51, 4096
    s_add_u32 s60, s60, 4096
    s_sub_u32 s46, s46, 1
    s_cbranch_scc0 L_gloop
    s_waitcnt vmcnt(16)
    v_mfma_f32_16x16x32_bf16 v[64:67], v[144:147], v[128:131], v[64:67]
    v_mfma_f32_16x16x32_bf16 v[64:67], v[176:179], v[160:163], v[64:67]
    v_mfma_f32_16x16x32_bf16 v[68:71], v[148:151], v[128:131], v[68:71]
    v_mfma_f32_16x16x32_bf16 v[68:71], v[180:183], v[160:163], v[68:71]
    v_mfma_f32_16x16x32_bf16 v[80:83], v[152:155], v[128:131], v[80:83]
    v_mfma_f32_16x16x32_bf16 v[80:83], v[184:187], v[160:163], v[80:83]
    v_mfma_f32_16x16x32_bf16 v[84:87], v[156:159], v[128:131], v[84:87]
    v_mfma_f32_16x16x32_bf16 v[84:87], v[188:191], v[160:163], v[84:87]
    v_mfma_f32_16x16x32_bf16 v[72:75], v[144:147], v[132:135], v[72:75]
    v_mfma_f32_16x16x32_bf16 v[72:75], v[176:179], v[164:167], v[72:75]
    v_mfma_f32_16x16x32_bf16 v[76:79], v[148:151], v[132:135], v[76:79]
    v_mfma_f32_16x16x32_bf16 v[76:79], v[180:183], v[164:167], v[76:79]
    v_mfma_f32_16x16x32_bf16 v[88:91], v[152:155], v[132:135], v[88:91]
    v_mfma_f32_16x16x32_bf16 v[88:91], v[184:187], v[164:167], v[88:91]
    v_mfma_f32_16x16x32_bf16 v[92:95], v[156:159], v[132:135], v[92:95]
    v_mfma_f32_16x16x32_bf16 v[92:95], v[188:191], v[164:167], v[92:95]
    v_mfma_f32_16x16x32_bf16 v[96:99], v[144:147], v[136:139], v[96:99]
    v_mfma_f32_16x16x32_bf16 v[96:99], v[176:179], v[168:171], v[96:99]
    v_mfma_f32_16x16x32_bf16 v[100:103], v[148:151], v[136:139], v[100:103]
    v_mfma_f32_16x16x32_bf16 v[100:103], v[180:183], v[168:171], v[100:103]
    v_mfma_f32_16x16x32_bf16 v[112:115], v[152:155], v[136:139], v[112:115]
    v_mfma_f32_16x16x32_bf16 v[112:115], v[184:187], v[168:171], v[112:115]
    v_mfma_f32_16x16x32_bf16 v[116:119], v[156:159], v[136:139], v[116:119]
    v_mfma_f32_16x16x32_bf16 v[116:119], v[188:191], v[168:171], v[116:119]
    v_mfma_f32_16x16x32_bf16 v[104:107], v[144:147], v[140:143], v[104:107]
    v_mfma_f32_16x16x32_bf16 v[104:107], v[176:179], v[172:175], v[104:107]
    v_mfma_f32_16x16x32_bf16 v[108:111], v[148:151], v[140:143], v[108:111]
    v_mfma_f32_16x16x32_bf16 v[108:111], v[180:183], v[172:175], v[108:111]
    v_mfma_f32_16x16x32_bf16 v[120:123], v[152:155], v[140:143], v[120:123]
    v_mfma_f32_16x16x32_bf16 v[120:123], v[184:187], v[172:175], v[120:123]
    v_mfma_f32_16x16x32_bf16 v[124:127], v[156:159], v[140:143], v[124:127]
    v_mfma_f32_16x16x32_bf16 v[124:127], v[188:191], v[172:175], v[124:127]
    buffer_load_dwordx4 v[128:131], v23, s[28:31], s49 offen offset:0 sc1
    buffer_load_dwordx4 v[132:135], v23, s[28:31], s49 offen offset:256 sc1
    buffer_load_dwordx4 v[136:139], v23, s[28:31], s50 offen offset:0 sc1
    buffer_load_dwordx4 v[140:143], v23, s[28:31], s50 offen offset:256 sc1
    buffer_load_dwordx4 v[144:147], v23, s[28:31], s51 offen offset:0 sc1
    buffer_load_dwordx4 v[148:151], v23, s[28:31], s51 offen offset:256 sc1
    buffer_load_dwordx4 v[152:155], v23, s[28:31], s60 offen offset:0 sc1
    buffer_load_dwordx4 v[156:159], v23, s[28:31], s60 offen offset:256 sc1
    buffer_load_dwordx4 v[160:163], v23, s[28:31], s49 offen offset:2048 sc1
    buffer_load_dwordx4 v[164:167], v23, s[28:31], s49 offen offset:2304 sc1
    buffer_load_dwordx4 v[168:171], v23, s[28:31], s50 offen offset:2048 sc1
    buffer_load_dwordx4 v[172:175], v23, s[28:31], s50 offen offset:2304 sc1
    buffer_load_dwordx4 v[176:179], v23, s[28:31], s51 offen offset:2048 sc1
    buffer_load_dwordx4 v[180:183], v23, s[28:31], s51 offen offset:2304 sc1
    buffer_load_dwordx4 v[184:187], v23, s[28:31], s60 offen offset:2048 sc1
    buffer_load_dwordx4 v[188:191], v23, s[28:31], s60 offen offset:2304 sc1
    s_add_u32 s49, s49, 4096
    s_add_u32 s50, s50, 4096
    s_add_u32 s51, s51, 4096
    s_add_u32 s60, s60, 4096
    s_and_b32 s48, s36, 1
    s_lshl_b32 s48, s48, 14
    s_mul_i32 s47, s36, 28672
    s_add_u32 s47, s47, 61440
    s_sub_u32 s47, s47, s48
    s_sub_u32 s51, s51, s47
    s_sub_u32 s60, s60, s47
    s_lshl_b32 s49, s96, 15
    s_add_u32 s49, s49, s48
    s_add_u32 s49, s49, 6291456
    s_add_u32 s50, s49, 4096
    s_add_u32 s41, s49, 8192
    s_add_u32 s42, s49, 12288
    s_waitcnt vmcnt(16)
    v_mfma_f32_16x16x32_bf16 v[64:67], v[208:211], v[192:195], v[64:67]
    v_mfma_f32_16x16x32_bf16 v[64:67], v[240:243], v[224:227], v[64:67]
    v_mfma_f32_16x16x32_bf16 v[68:71], v[212:215], v[192:195], v[68:71]
    v_mfma_f32_16x16x32_bf16 v[68:71], v[244:247], v[224:227], v[68:71]
    v_mfma_f32_16x16x32_bf16 v[80:83], v[216:219], v[192:195], v[80:83]
    v_mfma_f32_16x16x32_bf16 v[80:83], v[248:251], v[224:227], v[80:83]
    v_mfma_f32_16x16x32_bf16 v[84:87], v[220:223], v[192:195], v[84:87]
    v_mfma_f32_16x16x32_bf16 v[84:87], v[252:255], v[224:227], v[84:87]
    v_mfma_f32_16x16x32_bf16 v[72:75], v[208:211], v[196:199], v[72:75]
    v_mfma_f32_16x16x32_bf16 v[72:75], v[240:243], v[228:231], v[72:75]
    v_mfma_f32_16x16x32_bf16 v[76:79], v[212:215], v[196:199], v[76:79]
    v_mfma_f32_16x16x32_bf16 v[76:79], v[244:247], v[228:231], v[76:79]
    v_mfma_f32_16x16x32_bf16 v[88:91], v[216:219], v[196:199], v[88:91]
    v_mfma_f32_16x16x32_bf16 v[88:91], v[248:251], v[228:231], v[88:91]
    v_mfma_f32_16x16x32_bf16 v[92:95], v[220:223], v[196:199], v[92:95]
    v_mfma_f32_16x16x32_bf16 v[92:95], v[252:255], v[228:231], v[92:95]
    v_mfma_f32_16x16x32_bf16 v[96:99], v[208:211], v[200:203], v[96:99]
    v_mfma_f32_16x16x32_bf16 v[96:99], v[240:243], v[232:235], v[96:99]
    v_mfma_f32_16x16x32_bf16 v[100:103], v[212:215], v[200:203], v[100:103]
    v_mfma_f32_16x16x32_bf16 v[100:103], v[244:247], v[232:235], v[100:103]
    v_mfma_f32_16x16x32_bf16 v[112:115], v[216:219], v[200:203], v[112:115]
    v_mfma_f32_16x16x32_bf16 v[112:115], v[248:251], v[232:235], v[112:115]
    v_mfma_f32_16x16x32_bf16 v[116:119], v[220:223], v[200:203], v[116:119]
    v_mfma_f32_16x16x32_bf16 v[116:119], v[252:255], v[232:235], v[116:119]
    v_mfma_f32_16x16x32_bf16 v[104:107], v[208:211], v[204:207], v[104:107]
    v_mfma_f32_16x16x32_bf16 v[104:107], v[240:243], v[236:239], v[104:107]
    v_mfma_f32_16x16x32_bf16 v[108:111], v[212:215], v[204:207], v[108:111]
    v_mfma_f32_16x16x32_bf16 v[108:111], v[244:247], v[236:239], v[108:111]
    v_mfma_f32_16x16x32_bf16 v[120:123], v[216:219], v[204:207], v[120:123]
    v_mfma_f32_16x16x32_bf16 v[120:123], v[248:251], v[236:239], v[120:123]
    v_mfma_f32_16x16x32_bf16 v[124:127], v[220:223], v[204:207], v[124:127]
    v_mfma_f32_16x16x32_bf16 v[124:127], v[252:255], v[236:239], v[124:127]
    buffer_load_dwordx4 v[192:195], v23, s[28:31], s51 offen offset:0 sc1
    buffer_load_dwordx4 v[196:199], v23, s[28:31], s51 offen offset:256 sc1
    buffer_load_dwordx4 v[200:203], v23, s[28:31], s60 offen offset:0 sc1
    buffer_load_dwordx4 v[204:207], v23, s[28:31], s60 offen offset:256 sc1
    buffer_load_dwordx4 v[208:211], v23, s[28:31], s51 offen offset:2048 sc1
    buffer_load_dwordx4 v[212:215], v23, s[28:31], s51 offen offset:2304 sc1
    buffer_load_dwordx4 v[216:219], v23, s[28:31], s60 offen offset:2048 sc1
    buffer_load_dwordx4 v[220:223], v23, s[28:31], s60 offen offset:2304 sc1
    s_add_u32 s51, s51, 4096
    s_add_u32 s60, s60, 4096
    buffer_load_dwordx4 v[224:227], v23, s[28:31], s51 offen offset:0 sc1
    buffer_load_dwordx4 v[228:231], v23, s[28:31], s51 offen offset:256 sc1
    buffer_load_dwordx4 v[232:235], v23, s[28:31], s60 offen offset:0 sc1
    buffer_load_dwordx4 v[236:239], v23, s[28:31], s60 offen offset:256 sc1
    buffer_load_dwordx4 v[240:243], v23, s[28:31], s51 offen offset:2048 sc1
    buffer_load_dwordx4 v[244:247], v23, s[28:31], s51 offen offset:2304 sc1
    buffer_load_dwordx4 v[248:251], v23, s[28:31], s60 offen offset:2048 sc1
    buffer_load_dwordx4 v[252:255], v23, s[28:31], s60 offen offset:2304 sc1
    s_add_u32 s51, s51, 4096
    s_add_u32 s60, s60, 4096
    s_waitcnt vmcnt(16)
    v_mfma_f32_16x16x32_bf16 v[64:67], v[144:147], v[128:131], v[64:67]
    v_mfma_f32_16x16x32_bf16 v[64:67], v[176:179], v[160:163], v[64:67]
    v_mfma_f32_16x16x32_bf16 v[68:71], v[148:151], v[128:131], v[68:71]
    v_mfma_f32_16x16x32_bf16 v[68:71], v[180:183], v[160:163], v[68:71]
    v_mfma_f32_16x16x32_bf16 v[80:83], v[152:155], v[128:131], v[80:83]
    v_mfma_f32_16x16x32_bf16 v[80:83], v[184:187], v[160:163], v[80:83]
    v_mfma_f32_16x16x32_bf16 v[84:87], v[156:159], v[128:131], v[84:87]
    v_mfma_f32_16x16x32_bf16 v[84:87], v[188:191], v[160:163], v[84:87]
    v_mfma_f32_16x16x32_bf16 v[72:75], v[144:147], v[132:135], v[72:75]
    v_mfma_f32_16x16x32_bf16 v[72:75], v[176:179], v[164:167], v[72:75]
    v_mfma_f32_16x16x32_bf16 v[76:79], v[148:151], v[132:135], v[76:79]
    v_mfma_f32_16x16x32_bf16 v[76:79], v[180:183], v[164:167], v[76:79]
    v_mfma_f32_16x16x32_bf16 v[88:91], v[152:155], v[132:135], v[88:91]
    v_mfma_f32_16x16x32_bf16 v[88:91], v[184:187], v[164:167], v[88:91]
    v_mfma_f32_16x16x32_bf16 v[92:95], v[156:159], v[132:135], v[92:95]
    v_mfma_f32_16x16x32_bf16 v[92:95], v[188:191], v[164:167], v[92:95]
    v_mfma_f32_16x16x32_bf16 v[96:99], v[144:147], v[136:139], v[96:99]
    v_mfma_f32_16x16x32_bf16 v[96:99], v[176:179], v[168:171], v[96:99]
    v_mfma_f32_16x16x32_bf16 v[100:103], v[148:151], v[136:139], v[100:103]
    v_mfma_f32_16x16x32_bf16 v[100:103], v[180:183], v[168:171], v[100:103]
    v_mfma_f32_16x16x32_bf16 v[112:115], v[152:155], v[136:139], v[112:115]
    v_mfma_f32_16x16x32_bf16 v[112:115], v[184:187], v[168:171], v[112:115]
    v_mfma_f32_16x16x32_bf16 v[116:119], v[156:159], v[136:139], v[116:119]
    v_mfma_f32_16x16x32_bf16 v[116:119], v[188:191], v[168:171], v[116:119]
    v_mfma_f32_16x16x32_bf16 v[104:107], v[144:147], v[140:143], v[104:107]
    v_mfma_f32_16x16x32_bf16 v[104:107], v[176:179], v[172:175], v[104:107]
    v_mfma_f32_16x16x32_bf16 v[108:111], v[148:151], v[140:143], v[108:111]
    v_mfma_f32_16x16x32_bf16 v[108:111], v[180:183], v[172:175], v[108:111]
    v_mfma_f32_16x16x32_bf16 v[120:123], v[152:155], v[140:143], v[120:123]
    v_mfma_f32_16x16x32_bf16 v[120:123], v[184:187], v[172:175], v[120:123]
    v_mfma_f32_16x16x32_bf16 v[124:127], v[156:159], v[140:143], v[124:127]
    v_mfma_f32_16x16x32_bf16 v[124:127], v[188:191], v[172:175], v[124:127]
    buffer_load_dwordx4 v[128:131], v23, s[28:31], s51 offen offset:0 sc1
    buffer_load_dwordx4 v[132:135], v23, s[28:31], s51 offen offset:256 sc1
    buffer_load_dwordx4 v[136:139], v23, s[28:31], s60 offen offset:0 sc1
    buffer_load_dwordx4 v[140:143], v23, s[28:31], s60 offen offset:256 sc1
    buffer_load_dwordx4 v[144:147], v23, s[28:31], s51 offen offset:2048 sc1
    buffer_load_dwordx4 v[148:151], v23, s[28:31], s51 offen offset:2304 sc1
    buffer_load_dwordx4 v[152:155], v23, s[28:31], s60 offen offset:2048 sc1
    buffer_load_dwordx4 v[156:159], v23, s[28:31], s60 offen offset:2304 sc1
    s_add_u32 s51, s51, 4096
    s_add_u32 s60, s60, 4096
    buffer_load_dwordx4 v[160:163], v23, s[28:31], s51 offen offset:0 sc1
    buffer_load_dwordx4 v[164:167], v23, s[28:31], s51 offen offset:256 sc1
    buffer_load_dwordx4 v[168:171], v23, s[28:31], s60 offen offset:0 sc1
    buffer_load_dwordx4 v[172:175], v23, s[28:31], s60 offen offset:256 sc1
    buffer_load_dwordx4 v[176:179], v23, s[28:31], s51 offen offset:2048 sc1
    buffer_load_dwordx4 v[180:183], v23, s[28:31], s51 offen offset:2304 sc1
    buffer_load_dwordx4 v[184:187], v23, s[28:31], s60 offen offset:2048 sc1
    buffer_load_dwordx4 v[188:191], v23, s[28:31], s60 offen offset:2304 sc1
    s_add_u32 s51, s51, 4096
    s_add_u32 s60, s60, 4096
    s_mov_b32 s32, s98
    s_mov_b32 s33, s99
    s_mov_b32 s34, 2097152
    s_mov_b32 s35, 0x00020000
    s_barrier
    ds_write_b128 v11, v[96:99] offset:0
    ds_write_b128 v11, v[100:103] offset:1024
    ds_write_b128 v11, v[104:107] offset:2048
    ds_write_b128 v11, v[108:111] offset:3072
    ds_write_b128 v11, v[112:115] offset:4096
    ds_write_b128 v11, v[116:119] offset:5120
    ds_write_b128 v11, v[120:123] offset:6144
    ds_write_b128 v11, v[124:127] offset:7168
    s_waitcnt lgkmcnt(0)
    s_barrier
    buffer_load_dwordx4 v[32:35], v23, s[28:31], s49 offen offset:0 sc1
    buffer_load_dwordx4 v[36:39], v23, s[28:31], s49 offen offset:256 sc1
    buffer_load_dwordx4 v[40:43], v23, s[28:31], s49 offen offset:2048 sc1
    buffer_load_dwordx4 v[44:47], v23, s[28:31], s49 offen offset:2304 sc1
    buffer_load_dwordx4 v[48:51], v23, s[28:31], s50 offen offset:0 sc1
    buffer_load_dwordx4 v[52:55], v23, s[28:31], s50 offen offset:256 sc1
    buffer_load_dwordx4 v[56:59], v23, s[28:31], s50 offen offset:2048 sc1
    buffer_load_dwordx4 v[60:63], v23, s[28:31], s50 offen offset:2304 sc1
    ds_read_b128 v[96:99], v19 offset:0
    ds_read_b128 v[100:103], v19 offset:1024
    ds_read_b128 v[104:107], v19 offset:2048
    ds_read_b128 v[108:111], v19 offset:3072
    ds_read_b128 v[112:115], v19 offset:4096
    ds_read_b128 v[116:119], v19 offset:5120
    ds_read_b128 v[120:123], v19 offset:6144
    ds_read_b128 v[124:127], v19 offset:7168
    s_waitcnt lgkmcnt(4)
    v_pk_add_f32 v[64:65], v[64:65], v[96:97]
    v_pk_add_f32 v[66:67], v[66:67], v[98:99]
    v_pk_add_f32 v[68:69], v[68:69], v[100:101]
    v_pk_add_f32 v[70:71], v[70:71], v[102:103]
    v_pk_add_f32 v[72:73], v[72:73], v[104:105]
    v_pk_add_f32 v[74:75], v[74:75], v[106:107]
    v_pk_add_f32 v[76:77], v[76:77], v[108:109]
    v_pk_add_f32 v[78:79], v[78:79], v[110:111]
    s_waitcnt lgkmcnt(0)
    v_pk_add_f32 v[80:81], v[80:81], v[112:113]
    v_pk_add_f32 v[82:83], v[82:83], v[114:115]
    v_pk_add_f32 v[84:85], v[84:85], v[116:117]
    v_pk_add_f32 v[86:87], v[86:87], v[118:119]
    v_pk_add_f32 v[88:89], v[88:89], v[120:121]
    v_pk_add_f32 v[90:91], v[90:91], v[122:123]
    v_pk_add_f32 v[92:93], v[92:93], v[124:125]
    v_pk_add_f32 v[94:95], v[94:95], v[126:127]
L_oc0:
    s_waitcnt vmcnt(6)
L_ok0:
    v_max_u32 v16, v32, v33
    v_max3_u32 v16, v34, v35, v16
    v_max3_u32 v16, v36, v37, v16
    v_max3_u32 v16, v38, v39, v16
    v_cmp_eq_u32 vcc, -1, v16
    s_nop 0
    s_cmp_lg_u64 vcc, 0
    s_cbranch_scc1 L_or0
    v_mfma_f32_16x16x32_bf16 v[64:67], v[192:195], v[32:35], v[64:67]
    v_mfma_f32_16x16x32_bf16 v[68:71], v[196:199], v[32:35], v[68:71]
    v_mfma_f32_16x16x32_bf16 v[72:75], v[192:195], v[36:39], v[72:75]
    v_mfma_f32_16x16x32_bf16 v[76:79], v[196:199], v[36:39], v[76:79]
    v_mfma_f32_16x16x32_bf16 v[80:83], v[200:203], v[32:35], v[80:83]
    v_mfma_f32_16x16x32_bf16 v[84:87], v[204:207], v[32:35], v[84:87]
    v_mfma_f32_16x16x32_bf16 v[88:91], v[200:203], v[36:39], v[88:91]
    v_mfma_f32_16x16x32_bf16 v[92:95], v[204:207], v[36:39], v[92:95]
    buffer_load_dwordx4 v[192:195], v23, s[28:31], s41 offen offset:0 sc1
    buffer_load_dwordx4 v[196:199], v23, s[28:31], s41 offen offset:256 sc1
L_oc1:
    s_waitcnt vmcnt(6)
L_ok1:
    v_max_u32 v16, v40, v41
    v_max3_u32 v16, v42, v43, v16
    v_max3_u32 v16, v44, v45, v16
    v_max3_u32 v16, v46, v47, v16
    v_cmp_eq_u32 vcc, -1, v16
    s_nop 0
    s_cmp_lg_u64 vcc, 0
    s_cbranch_scc1 L_or1
    v_mfma_f32_16x16x32_bf16 v[64:67], v[208:211], v[40:43], v[64:67]
    v_mfma_f32_16x16x32_bf16 v[68:71], v[212:215], v[40:43], v[68:71]
    v_mfma_f32_16x16x32_bf16 v[72:75], v[208:211], v[44:47], v[72:75]
    v_mfma_f32_16x16x32_bf16 v[76:79], v[212:215], v[44:47], v[76:79]
    v_mfma_f32_16x16x32_bf16 v[80:83], v[216:219], v[40:43], v[80:83]
    v_mfma_f32_16x16x32_bf16 v[84:87], v[220:223], v[40:43], v[84:87]
    v_mfma_f32_16x16x32_bf16 v[88:91], v[216:219], v[44:47], v[88:91]
    v_mfma_f32_16x16x32_bf16 v[92:95], v[220:223], v[44:47], v[92:95]
    buffer_load_dwordx4 v[208:211], v23, s[28:31], s41 offen offset:2048 sc1
    buffer_load_dwordx4 v[212:215], v23, s[28:31], s41 offen offset:2304 sc1
L_oc2:
    s_waitcnt vmcnt(6)
L_ok2:
    v_max_u32 v16, v48, v49
    v_max3_u32 v16, v50, v51, v16
    v_max3_u32 v16, v52, v53, v16
    v_max3_u32 v16, v54, v55, v16
    v_cmp_eq_u32 vcc, -1, v16
    s_nop 0
    s_cmp_lg_u64 vcc, 0
    s_cbranch_scc1 L_or2
    v_mfma_f32_16x16x32_bf16 v[64:67], v[224:227], v[48:51], v[64:67]
    v_mfma_f32_16x16x32_bf16 v[68:71], v[228:231], v[48:51], v[68:71]
    v_mfma_f32_16x16x32_bf16 v[72:75], v[224:227], v[52:55], v[72:75]
    v_mfma_f32_16x16x32_bf16 v[76:79], v[228:231], v[52:55], v[76:79]
    v_mfma_f32_16x16x32_bf16 v[80:83], v[232:235], v[48:51], v[80:83]
    v_mfma_f32_16x16x32_bf16 v[84:87], v[236:239], v[48:51], v[84:87]
    v_mfma_f32_16x16x32_bf16 v[88:91], v[232:235], v[52:55], v[88:91]
    v_mfma_f32_16x16x32_bf16 v[92:95], v[236:239], v[52:55], v[92:95]
    buffer_load_dwordx4 v[224:227], v23, s[28:31], s42 offen offset:0 sc1
    buffer_load_dwordx4 v[228:231], v23, s[28:31], s42 offen offset:256 sc1
L_oc3:
    s_waitcnt vmcnt(6)
L_ok3:
    v_max_u32 v16, v56, v57
    v_max3_u32 v16, v58, v59, v16
    v_max3_u32 v16, v60, v61, v16
    v_max3_u32 v16, v62, v63, v16
    v_cmp_eq_u32 vcc, -1, v16
    s_nop 0
    s_cmp_lg_u64 vcc, 0
    s_cbranch_scc1 L_or3
    v_mfma_f32_16x16x32_bf16 v[64:67], v[240:243], v[56:59], v[64:67]
    v_mfma_f32_16x16x32_bf16 v[68:71], v[244:247], v[56:59], v[68:71]
    v_mfma_f32_16x16x32_bf16 v[72:75], v[240:243], v[60:63], v[72:75]
    v_mfma_f32_16x16x32_bf16 v[76:79], v[244:247], v[60:63], v[76:79]
    v_mfma_f32_16x16x32_bf16 v[80:83], v[248:251], v[56:59], v[80:83]
    v_mfma_f32_16x16x32_bf16 v[84:87], v[252:255], v[56:59], v[84:87]
    v_mfma_f32_16x16x32_bf16 v[88:91], v[248:251], v[60:63], v[88:91]
    v_mfma_f32_16x16x32_bf16 v[92:95], v[252:255], v[60:63], v[92:95]
    buffer_load_dwordx4 v[240:243], v23, s[28:31], s42 offen offset:2048 sc1
    buffer_load_dwordx4 v[244:247], v23, s[28:31], s42 offen offset:2304 sc1
L_oc4:
    s_waitcnt vmcnt(6)
L_ok4:
    v_max_u32 v16, v192, v193
    v_max3_u32 v16, v194, v195, v16
    v_max3_u32 v16, v196, v197, v16
    v_max3_u32 v16, v198, v199, v16
    v_cmp_eq_u32 vcc, -1, v16
    s_nop 0
    s_cmp_lg_u64 vcc, 0
    s_cbranch_scc1 L_or4
    v_mfma_f32_16x16x32_bf16 v[64:67], v[128:131], v[192:195], v[64:67]
    v_mfma_f32_16x16x32_bf16 v[68:71], v[132:135], v[192:195], v[68:71]
    v_mfma_f32_16x16x32_bf16 v[72:75], v[128:131], v[196:199], v[72:75]
    v_mfma_f32_16x16x32_bf16 v[76:79], v[132:135], v[196:199], v[76:79]
    v_mfma_f32_16x16x32_bf16 v[80:83], v[136:139], v[192:195], v[80:83]
    v_mfma_f32_16x16x32_bf16 v[84:87], v[140:143], v[192:195], v[84:87]
    v_mfma_f32_16x16x32_bf16 v[88:91], v[136:139], v[196:199], v[88:91]
    v_mfma_f32_16x16x32_bf16 v[92:95], v[140:143], v[196:199], v[92:95]
L_oc5:
    s_waitcnt vmcnt(4)
L_ok5:
    v_max_u32 v16, v208, v209
    v_max3_u32 v16, v210, v211, v16
    v_max3_u32 v16, v212, v213, v16
    v_max3_u32 v16, v214, v215, v16
    v_cmp_eq_u32 vcc, -1, v16
    s_nop 0
    s_cmp_lg_u64 vcc, 0
    s_cbranch_scc1 L_or5
    v_mfma_f32_16x16x32_bf16 v[64:67], v[144:147], v[208:211], v[64:67]
    v_mfma_f32_16x16x32_bf16 v[68:71], v[148:151], v[208:211], v[68:71]
    v_mfma_f32_16x16x32_bf16 v[72:75], v[144:147], v[212:215], v[72:75]
    v_mfma_f32_16x16x32_bf16 v[76:79], v[148:151], v[212:215], v[76:79]
    v_mfma_f32_16x16x32_bf16 v[80:83], v[152:155], v[208:211], v[80:83]
    v_mfma_f32_16x16x32_bf16 v[84:87], v[156:159], v[208:211], v[84:87]
    v_mfma_f32_16x16x32_bf16 v[88:91], v[152:155], v[212:215], v[88:91]
    v_mfma_f32_16x16x32_bf16 v[92:95], v[156:159], v[212:215], v[92:95]
L_oc6:
    s_waitcnt vmcnt(2)
L_ok6:
    v_max_u32 v16, v224, v225
    v_max3_u32 v16, v226, v227, v16
    v_max3_u32 v16, v228, v229, v16
    v_max3_u32 v16, v230, v231, v16
    v_cmp_eq_u32 vcc, -1, v16
    s_nop 0
    s_cmp_lg_u64 vcc, 0
    s_cbranch_scc1 L_or6
    v_mfma_f32_16x16x32_bf16 v[64:67], v[160:163], v[224:227], v[64:67]
    v_mfma_f32_16x16x32_bf16 v[68:71], v[164:167], v[224:227], v[68:71]
    v_mfma_f32_16x16x32_bf16 v[72:75], v[160:163], v[228:231], v[72:75]
    v_mfma_f32_16x16x32_bf16 v[76:79], v[164:167], v[228:231], v[76:79]
    v_mfma_f32_16x16x32_bf16 v[80:83], v[168:171], v[224:227], v[80:83]
    v_mfma_f32_16x16x32_bf16 v[84:87], v[172:175], v[224:227], v[84:87]
    v_mfma_f32_16x16x32_bf16 v[88:91], v[168:171], v[228:231], v[88:91]
    v_mfma_f32_16x16x32_bf16 v[92:95], v[172:175], v[228:231], v[92:95]
L_oc7:
    s_waitcnt vmcnt(0)
L_ok7:
    v_max_u32 v16, v240, v241
    v_max3_u32 v16, v242, v243, v16
    v_max3_u32 v16, v244, v245, v16
    v_max3_u32 v16, v246, v247, v16
    v_cmp_eq_u32 vcc, -1, v16
    s_nop 0
    s_cmp_lg_u64 vcc, 0
    s_cbranch_scc1 L_or7
    v_mfma_f32_16x16x32_bf16 v[80:83], v[184:187], v[240:243], v[80:83]
    v_mfma_f32_16x16x32_bf16 v[84:87], v[188:191], v[240:243], v[84:87]
    v_mfma_f32_16x16x32_bf16 v[88:91], v[184:187], v[244:247], v[88:91]
    v_mfma_f32_16x16x32_bf16 v[92:95], v[188:191], v[244:247], v[92:95]
    v_mfma_f32_16x16x32_bf16 v[64:67], v[176:179], v[240:243], v[64:67]
    v_mfma_f32_16x16x32_bf16 v[68:71], v[180:183], v[240:243], v[68:71]
    v_mfma_f32_16x16x32_bf16 v[72:75], v[176:179], v[244:247], v[72:75]
    v_mfma_f32_16x16x32_bf16 v[76:79], v[180:183], v[244:247], v[76:79]
    s_nop 1
    ds_write_b128 v12, v[80:83] offset:0
    ds_write_b128 v12, v[84:87] offset:1024
    ds_write_b128 v12, v[88:91] offset:2048
    ds_write_b128 v12, v[92:95] offset:3072
    s_waitcnt lgkmcnt(0)
    s_barrier
    ds_read_b128 v[128:131], v19 offset:32768
    ds_read_b128 v[132:135], v19 offset:33792
    ds_read_b128 v[136:139], v19 offset:34816
    ds_read_b128 v[140:143], v19 offset:35840
    s_waitcnt lgkmcnt(3)
    v_pk_add_f32 v[64:65], v[64:65], v[128:129]
    v_pk_add_f32 v[66:67], v[66:67], v[130:131]
    s_waitcnt lgkmcnt(2)
    v_pk_add_f32 v[68:69], v[68:69], v[132:133]
    v_pk_add_f32 v[70:71], v[70:71], v[134:135]
    s_waitcnt lgkmcnt(1)
    v_pk_add_f32 v[72:73], v[72:73], v[136:137]
    v_pk_add_f32 v[74:75], v[74:75], v[138:139]
    s_waitcnt lgkmcnt(0)
    v_pk_add_f32 v[76:77], v[76:77], v[140:141]
    v_pk_add_f32 v[78:79], v[78:79], v[142:143]
    v_cvt_pk_bf16_f32 v80, v64, v65
    v_cvt_pk_bf16_f32 v81, v66, v67
    v_cvt_pk_bf16_f32 v82, v68, v69
    v_cvt_pk_bf16_f32 v83, v70, v71
    v_cvt_pk_bf16_f32 v84, v72, v73
    v_cvt_pk_bf16_f32 v85, v74, v75
    v_cvt_pk_bf16_f32 v86, v76, v77
    v_cvt_pk_bf16_f32 v87, v78, v79
    s_nop 0
    v_permlane16_swap_b32 v80, v82
    v_permlane16_swap_b32 v81, v83
    v_permlane16_swap_b32 v84, v86
    v_permlane16_swap_b32 v85, v87
    buffer_store_dwordx4 v[80:83], v13, s[32:35], s61 offen
    buffer_store_dwordx4 v[84:87], v13, s[32:35], s0 offen
L_end:
    s_endpgm
L_or0:
    s_sub_u32 s63, s63, 1
    s_cbranch_scc1 L_end
    buffer_load_dwordx4 v[32:35], v23, s[28:31], s49 offen offset:0 sc1
    buffer_load_dwordx4 v[36:39], v23, s[28:31], s49 offen offset:256 sc1
    buffer_load_dwordx4 v[40:43], v23, s[28:31], s49 offen offset:2048 sc1
    buffer_load_dwordx4 v[44:47], v23, s[28:31], s49 offen offset:2304 sc1
    buffer_load_dwordx4 v[48:51], v23, s[28:31], s50 offen offset:0 sc1
    buffer_load_dwordx4 v[52:55], v23, s[28:31], s50 offen offset:256 sc1
    buffer_load_dwordx4 v[56:59], v23, s[28:31], s50 offen offset:2048 sc1
    buffer_load_dwordx4 v[60:63], v23, s[28:31], s50 offen offset:2304 sc1
    s_waitcnt vmcnt(6)
    s_branch L_ok0
L_or1:
    s_sub_u32 s63, s63, 1
    s_cbranch_scc1 L_end
    buffer_load_dwordx4 v[40:43], v23, s[28:31], s49 offen offset:2048 sc1
    buffer_load_dwordx4 v[44:47], v23, s[28:31], s49 offen offset:2304 sc1
    buffer_load_dwordx4 v[48:51], v23, s[28:31], s50 offen offset:0 sc1
    buffer_load_dwordx4 v[52:55], v23, s[28:31], s50 offen offset:256 sc1
    buffer_load_dwordx4 v[56:59], v23, s[28:31], s50 offen offset:2048 sc1
    buffer_load_dwordx4 v[60:63], v23, s[28:31], s50 offen offset:2304 sc1
    buffer_load_dwordx4 v[192:195], v23, s[28:31], s41 offen offset:0 sc1
    buffer_load_dwordx4 v[196:199], v23, s[28:31], s41 offen offset:256 sc1
    s_waitcnt vmcnt(6)
    s_branch L_ok1
L_or2:
    s_sub_u32 s63, s63, 1
    s_cbranch_scc1 L_end
    buffer_load_dwordx4 v[48:51], v23, s[28:31], s50 offen offset:0 sc1
    buffer_load_dwordx4 v[52:55], v23, s[28:31], s50 offen offset:256 sc1
    buffer_load_dwordx4 v[56:59], v23, s[28:31], s50 offen offset:2048 sc1
    buffer_load_dwordx4 v[60:63], v23, s[28:31], s50 offen offset:2304 sc1
    buffer_load_dwordx4 v[192:195], v23, s[28:31], s41 offen offset:0 sc1
    buffer_load_dwordx4 v[196:199], v23, s[28:31], s41 offen offset:256 sc1
    buffer_load_dwordx4 v[208:211], v23, s[28:31], s41 offen offset:2048 sc1
    buffer_load_dwordx4 v[212:215], v23, s[28:31], s41 offen offset:2304 sc1
    s_waitcnt vmcnt(6)
    s_branch L_ok2
L_or3:
    s_sub_u32 s63, s63, 1
    s_cbranch_scc1 L_end
    buffer_load_dwordx4 v[56:59], v23, s[28:31], s50 offen offset:2048 sc1
    buffer_load_dwordx4 v[60:63], v23, s[28:31], s50 offen offset:2304 sc1
    buffer_load_dwordx4 v[192:195], v23, s[28:31], s41 offen offset:0 sc1
    buffer_load_dwordx4 v[196:199], v23, s[28:31], s41 offen offset:256 sc1
    buffer_load_dwordx4 v[208:211], v23, s[28:31], s41 offen offset:2048 sc1
    buffer_load_dwordx4 v[212:215], v23, s[28:31], s41 offen offset:2304 sc1
    buffer_load_dwordx4 v[224:227], v23, s[28:31], s42 offen offset:0 sc1
    buffer_load_dwordx4 v[228:231], v23, s[28:31], s42 offen offset:256 sc1
    s_waitcnt vmcnt(6)
    s_branch L_ok3
L_or4:
    s_sub_u32 s63, s63, 1
    s_cbranch_scc1 L_end
    buffer_load_dwordx4 v[192:195], v23, s[28:31], s41 offen offset:0 sc1
    buffer_load_dwordx4 v[196:199], v23, s[28:31], s41 offen offset:256 sc1
    buffer_load_dwordx4 v[208:211], v23, s[28:31], s41 offen offset:2048 sc1
    buffer_load_dwordx4 v[212:215], v23, s[28:31], s41 offen offset:2304 sc1
    buffer_load_dwordx4 v[224:227], v23, s[28:31], s42 offen offset:0 sc1
    buffer_load_dwordx4 v[228:231], v23, s[28:31], s42 offen offset:256 sc1
    buffer_load_dwordx4 v[240:243], v23, s[28:31], s42 offen offset:2048 sc1
    buffer_load_dwordx4 v[244:247], v23, s[28:31], s42 offen offset:2304 sc1
    s_waitcnt vmcnt(6)
    s_branch L_ok4
L_or5:
    s_sub_u32 s63, s63, 1
    s_cbranch_scc1 L_end
    buffer_load_dwordx4 v[208:211], v23, s[28:31], s41 offen offset:2048 sc1
    buffer_load_dwordx4 v[212:215], v23, s[28:31], s41 offen offset:2304 sc1
    buffer_load_dwordx4 v[224:227], v23, s[28:31], s42 offen offset:0 sc1
    buffer_load_dwordx4 v[228:231], v23, s[28:31], s42 offen offset:256 sc1
    buffer_load_dwordx4 v[240:243], v23, s[28:31], s42 offen offset:2048 sc1
    buffer_load_dwordx4 v[244:247], v23, s[28:31], s42 offen offset:2304 sc1
    s_waitcnt vmcnt(4)
    s_branch L_ok5
L_or6:
    s_sub_u32 s63, s63, 1
    s_cbranch_scc1 L_end
    buffer_load_dwordx4 v[224:227], v23, s[28:31], s42 offen offset:0 sc1
    buffer_load_dwordx4 v[228:231], v23, s[28:31], s42 offen offset:256 sc1
    buffer_load_dwordx4 v[240:243], v23, s[28:31], s42 offen offset:2048 sc1
    buffer_load_dwordx4 v[244:247], v23, s[28:31], s42 offen offset:2304 sc1
    s_waitcnt vmcnt(2)
    s_branch L_ok6
L_or7:
    s_sub_u32 s63, s63, 1
    s_cbranch_scc1 L_end
    buffer_load_dwordx4 v[240:243], v23, s[28:31], s42 offen offset:2048 sc1
    buffer_load_dwordx4 v[244:247], v23, s[28:31], s42 offen offset:2304 sc1
    s_waitcnt vmcnt(0)
    s_branch L_ok7
L_code_end:
.section .rodata,"a"
.p2align 6
.amdhsa_kernel parallel_sum__softmax_full_mha__swiglu_ffn__prompt_kernel
  .amdhsa_next_free_vgpr 256
  .amdhsa_next_free_sgpr 102
  .amdhsa_accum_offset 256
  .amdhsa_group_segment_fixed_size 0
  .amdhsa_kernarg_size 80
  .amdhsa_user_sgpr_count 2
  .amdhsa_user_sgpr_kernarg_segment_ptr 1
  .amdhsa_system_sgpr_workgroup_id_x 1
.end_amdhsa_kernel
```
